```python
import torch

def _softmax(x, axis=-1):
    return torch.softmax(x, dim=axis)
def _gelu(x):
    return torch.nn.functional.gelu(x, approximate="tanh")
def _silu(x):
    return torch.nn.functional.silu(x)
def _sigmoid(x):
    return torch.sigmoid(x)
def _layernorm(x, axis=-1, eps=1e-5):
    m = x.mean(dim=axis, keepdim=True)
    v = x.var(dim=axis, keepdim=True, unbiased=False)
    return (x - m) / torch.sqrt(v + eps)
def _scatter_add(tgt, idx, src, axis=0):
    return tgt.clone().index_add_(axis, idx, src)
def _segment_sum(src, seg, n):
    out = torch.zeros((n,) + src.shape[1:], dtype=src.dtype)
    return out.index_add_(0, seg, src)
def _pad(x, pw):
    flat = tuple(v for pair in reversed(pw) for v in pair)
    return torch.nn.functional.pad(x, flat)

kernel_name = 'interleave_layers__grouped_kv_mqa__sliding_block__prompt'

def setup_inputs():

    _w = (lambda a: (lambda t: t.to(torch.bfloat16) if t.is_floating_point() else t)(torch.as_tensor(a)))
    def _A_setup():
        B, S, D, H = 1, 2048, 448, 16
        Dh = D // H
        return {
            "x": _w((lambda *s: torch.randn(*s, dtype=torch.bfloat16) * 0.05)(B, S, D)),
            "wq": _w((lambda *s: torch.randn(*s, dtype=torch.bfloat16) * 0.05)(D, H * Dh)),
            "wk": _w((lambda *s: torch.randn(*s, dtype=torch.bfloat16) * 0.05)(D, Dh)),
            "wv": _w((lambda *s: torch.randn(*s, dtype=torch.bfloat16) * 0.05)(D, Dh)),
            "wo": _w((lambda *s: torch.randn(*s, dtype=torch.bfloat16) * 0.05)(H * Dh, D)),
        }
    _A_in = _A_setup()

    def _B_setup():
        B, S, D = 1, 2048, 448
        return {
            "x": _w((lambda *s: torch.randn(*s, dtype=torch.bfloat16) * 0.05)(B, S, D)),
            "wqkv": _w((lambda *s: torch.randn(*s, dtype=torch.bfloat16) * 0.05)(D, 3 * D)),
            "wo": _w((lambda *s: torch.randn(*s, dtype=torch.bfloat16) * 0.05)(D, D)),
        }
    _B_in = _B_setup()

    return {
        "A_x": _A_in["x"],
        "A_wq": _A_in["wq"],
        "A_wk": _A_in["wk"],
        "A_wv": _A_in["wv"],
        "A_wo": _A_in["wo"],
        "B_x": _B_in["x"],
        "B_wqkv": _B_in["wqkv"],
        "B_wo": _B_in["wo"],
    }

def reference(A_x, A_wq, A_wk, A_wv, A_wo, B_x, B_wqkv, B_wo):
    def _A_ref(x, wq, wk, wv, wo):
        B, S, D = x.shape
        H = 16
        Dh = D // H
        q = (lambda x, *d: x.permute(*d))((x @ wq).reshape(B, S, H, Dh), 0, 2, 1, 3)
        k = x @ wk
        v = x @ wv
        scores = torch.einsum("bhqd,bkd->bhqk", q, k) * (Dh ** -0.5)
        p = _softmax(scores, axis=-1)
        o = torch.einsum("bhqk,bkd->bhqd", p, v)
        return (lambda x, *d: x.permute(*d))(o, 0, 2, 1, 3).reshape(B, S, H * Dh) @ wo

    def _B_ref(x, wqkv, wo):
        B, S, D = x.shape
        H = 16; Dh = D // H; W = 256
        qkv = (lambda x, *d: x.permute(*d))((x @ wqkv).reshape(B, S, 3, H, Dh), 2, 0, 3, 1, 4)
        q, k, v = qkv[0], qkv[1], qkv[2]
        scores = torch.einsum("bhqd,bhkd->bhqk", q, k) * (Dh ** -0.5)
        idx = torch.arange(S)
        mask = (idx[:, None] - idx[None, :] >= 0) & (idx[:, None] - idx[None, :] < W)
        scores = torch.where(mask[None, None], scores, -1e9)
        p = _softmax(scores, axis=-1)
        o = torch.einsum("bhqk,bhkd->bhqd", p, v)
        return (lambda x, *d: x.permute(*d))(o, 0, 2, 1, 3).reshape(B, S, D) @ wo

    x = A_x
    x = x + _A_ref(_layernorm(x, axis=-1), A_wq, A_wk, A_wv, A_wo)
    x = x + _B_ref(_layernorm(x, axis=-1), B_wqkv, B_wo)
    x = x + _A_ref(_layernorm(x, axis=-1), A_wq, A_wk, A_wv, A_wo)
    x = x + _B_ref(_layernorm(x, axis=-1), B_wqkv, B_wo)
    return x
```

```asm
; @launch kernel=prep_kernel grid=(1272,1,1) block=(256,1,1) lds=2048
; @launch kernel=main_kernel grid=(256,1,1) block=(256,1,1) lds=156672
.amdgcn_target "amdgcn-amd-amdhsa--gfx950"
.text
.globl prep_kernel
.p2align 8
.type prep_kernel,@function
prep_kernel:
    s_cmp_ge_u32 s2, 1272
    s_cbranch_scc1 P_done
    s_getpc_b64 s[58:59]
P_pc:
    v_lshlrev_b32 v44, 4, v0
    v_min_u32 v44, P_done-P_pc-16, v44
    global_load_dwordx4 v[44:47], v44, s[58:59]
    s_load_dwordx16 s[16:31], s[0:1], 0
    s_load_dwordx2 s[32:33], s[0:1], 80
    v_and_b32 v1, 63, v0
    v_lshrrev_b32 v4, 6, v0
    v_and_b32 v2, 31, v0
    v_bfe_u32 v3, v0, 5, 1
    v_readfirstlane_b32 s3, v4
    v_lshlrev_b32 v5, 4, v1
    v_mov_b32 v8, 0
    v_mov_b32 v9, 0
    v_mov_b32 v16, 0
    v_mov_b32 v17, 0
    v_mov_b32 v18, 0
    v_mov_b32 v19, 0
    v_mov_b32 v20, 0
    v_mov_b32 v21, 0
    v_mov_b32 v22, 0
    v_mov_b32 v23, 0
    s_waitcnt lgkmcnt(0)
    s_mov_b32 s8, s32
    s_mov_b32 s9, s33
    s_mov_b32 s10, 48574464
    s_mov_b32 s11, 0x00020000
    s_cmp_lt_u32 s2, 248
    s_cbranch_scc1 P_fill
    s_sub_u32 s2, s2, 248
    s_lshl_b32 s4, s2, 2
    s_add_u32 s4, s4, s3
    s_cmp_ge_u32 s2, 800
    s_cbranch_scc1 P_x0
    s_cmp_ge_u32 s2, 736
    s_cbranch_scc1 P_st
    s_cmp_ge_u32 s2, 672
    s_cbranch_scc1 P_cs
    s_cmp_ge_u32 s2, 336
    s_cbranch_scc1 P_wb
    s_mov_b32 s40, 0
    s_mov_b32 s41, 896
    s_mov_b32 s42, 1792
    s_mov_b32 s43, 2688
    s_mov_b32 s44, 7168
    s_mov_b32 s45, 8064
    s_mov_b32 s46, 8960
    s_mov_b32 s47, 9856
    s_cmp_ge_u32 s2, 112
    s_cbranch_scc1 P_wo
    s_mul_i32 s5, s4, 2341
    s_lshr_b32 s5, s5, 16
    s_mul_i32 s6, s5, 28
    s_sub_u32 s6, s4, s6
    s_mov_b32 s12, s18
    s_mov_b32 s13, s19
    s_mov_b32 s14, 401408
    s_mov_b32 s15, 0x00020000
    s_lshl_b32 s7, s6, 4
    v_lshl_add_u32 v6, v3, 2, s7
    s_mul_i32 s34, s5, 56
    v_mul_u32_u24 v7, 896, v6
    v_lshl_add_u32 v7, v2, 1, v7
    v_add_u32 v7, s34, v7
    v_cmp_gt_u32 vcc, 28, v2
    s_and_saveexec_b64 s[36:37], vcc
    buffer_load_ushort v16, v7, s[12:15], s40 offen
    buffer_load_ushort v17, v7, s[12:15], s41 offen
    buffer_load_ushort v18, v7, s[12:15], s42 offen
    buffer_load_ushort v19, v7, s[12:15], s43 offen
    buffer_load_ushort v20, v7, s[12:15], s44 offen
    buffer_load_ushort v21, v7, s[12:15], s45 offen
    buffer_load_ushort v22, v7, s[12:15], s46 offen
    buffer_load_ushort v23, v7, s[12:15], s47 offen
    s_andn2_b64 exec, s[36:37], exec
    s_and_b32 s34, s5, 7
    s_cmp_eq_u32 s34, 7
    s_cbranch_scc1 P_wqa_st
    s_cmp_ge_u32 s5, 8
    s_cbranch_scc1 P_wqa_v
    s_mov_b32 s12, s20
    s_mov_b32 s13, s21
    s_lshl_b32 s34, s5, 3
    s_branch P_wqa_kv
P_wqa_v:
    s_mov_b32 s12, s22
    s_mov_b32 s13, s23
    s_sub_u32 s34, s5, 8
    s_lshl_b32 s34, s34, 3
P_wqa_kv:
    s_mov_b32 s14, 25088
    s_mov_b32 s15, 0x00020000
    s_sub_u32 s34, s34, 56
    v_mul_u32_u24 v7, 56, v6
    v_lshl_add_u32 v7, v2, 1, v7
    v_add_u32 v7, s34, v7
    buffer_load_ushort v16, v7, s[12:15], 0 offen offset:0
    buffer_load_ushort v17, v7, s[12:15], 0 offen offset:56
    buffer_load_ushort v18, v7, s[12:15], 0 offen offset:112
    buffer_load_ushort v19, v7, s[12:15], 0 offen offset:168
    buffer_load_ushort v20, v7, s[12:15], 0 offen offset:448
    buffer_load_ushort v21, v7, s[12:15], 0 offen offset:504
    buffer_load_ushort v22, v7, s[12:15], 0 offen offset:560
    buffer_load_ushort v23, v7, s[12:15], 0 offen offset:616
P_wqa_st:
    s_mov_b64 exec, s[36:37]
    s_lshl_b32 s34, s4, 10
    s_add_u32 s34, s34, 0
    s_waitcnt vmcnt(0)
    v_lshl_or_b32 v8, v17, 16, v16
    v_lshl_or_b32 v9, v19, 16, v18
    v_lshl_or_b32 v10, v21, 16, v20
    v_lshl_or_b32 v11, v23, 16, v22
    buffer_store_dwordx4 v[8:11], v5, s[8:11], s34 offen
    s_endpgm
P_wo:
    s_sub_u32 s4, s4, 448
    s_cmp_ge_u32 s2, 224
    s_cbranch_scc1 P_wob
    s_mov_b32 s12, s24
    s_mov_b32 s13, s25
    s_mov_b32 s35, 458752
    s_branch P_wo2
P_wob:
    s_sub_u32 s4, s4, 448
    s_mov_b32 s12, s30
    s_mov_b32 s13, s31
    s_mov_b32 s35, 917504
P_wo2:
    s_mov_b32 s14, 401408
    s_mov_b32 s15, 0x00020000
    s_lshr_b32 s5, s4, 5
    s_and_b32 s6, s4, 31
    s_lshr_b32 s7, s6, 1
    s_mul_i32 s7, s7, 28
    s_and_b32 s34, s6, 1
    s_lshl_b32 s38, s34, 4
    s_add_u32 s7, s7, s38
    v_lshl_add_u32 v6, v3, 2, s7
    v_mul_u32_u24 v7, 896, v6
    v_lshl_add_u32 v7, v2, 1, v7
    s_lshl_b32 s38, s5, 6
    v_add_u32 v7, s38, v7
    buffer_load_ushort v16, v7, s[12:15], s40 offen
    buffer_load_ushort v17, v7, s[12:15], s41 offen
    buffer_load_ushort v18, v7, s[12:15], s42 offen
    buffer_load_ushort v19, v7, s[12:15], s43 offen
    buffer_load_ushort v20, v7, s[12:15], s44 offen
    buffer_load_ushort v21, v7, s[12:15], s45 offen
    buffer_load_ushort v22, v7, s[12:15], s46 offen
    buffer_load_ushort v23, v7, s[12:15], s47 offen
    v_and_b32 v6, s34, v3
    v_cmp_eq_u32 vcc, 0, v6
    s_lshl_b32 s34, s4, 10
    s_add_u32 s34, s34, s35
    s_waitcnt vmcnt(0)
    v_lshl_or_b32 v8, v17, 16, v16
    v_lshl_or_b32 v9, v19, 16, v18
    v_lshl_or_b32 v10, v21, 16, v20
    v_lshl_or_b32 v11, v23, 16, v22
    v_cndmask_b32 v10, 0, v10, vcc
    v_cndmask_b32 v11, 0, v11, vcc
    buffer_store_dwordx4 v[8:11], v5, s[8:11], s34 offen
    s_endpgm
P_wb:
    s_mov_b32 s40, 0
    s_mov_b32 s41, 2688
    s_mov_b32 s42, 5376
    s_mov_b32 s43, 8064
    s_mov_b32 s44, 21504
    s_mov_b32 s45, 24192
    s_mov_b32 s46, 26880
    s_mov_b32 s47, 29568
    s_mov_b32 s12, s28
    s_mov_b32 s13, s29
    s_mov_b32 s14, 1204224
    s_mov_b32 s15, 0x00020000
    s_sub_u32 s4, s4, 1344
    s_mul_i32 s5, s4, 2341
    s_lshr_b32 s5, s5, 16
    s_mul_i32 s6, s5, 28
    s_sub_u32 s6, s4, s6
    s_mul_i32 s7, s5, 21846
    s_lshr_b32 s7, s7, 16
    s_mul_i32 s34, s7, 3
    s_sub_u32 s34, s5, s34
    s_mul_i32 s34, s34, 896
    s_mul_i32 s7, s7, 56
    s_add_u32 s34, s34, s7
    s_lshl_b32 s7, s6, 4
    v_lshl_add_u32 v6, v3, 2, s7
    v_mul_u32_u24 v7, 2688, v6
    v_lshl_add_u32 v7, v2, 1, v7
    v_add_u32 v7, s34, v7
    v_cmp_gt_u32 vcc, 28, v2
    s_and_saveexec_b64 s[36:37], vcc
    buffer_load_ushort v16, v7, s[12:15], s40 offen
    buffer_load_ushort v17, v7, s[12:15], s41 offen
    buffer_load_ushort v18, v7, s[12:15], s42 offen
    buffer_load_ushort v19, v7, s[12:15], s43 offen
    buffer_load_ushort v20, v7, s[12:15], s44 offen
    buffer_load_ushort v21, v7, s[12:15], s45 offen
    buffer_load_ushort v22, v7, s[12:15], s46 offen
    buffer_load_ushort v23, v7, s[12:15], s47 offen
    s_mov_b64 exec, s[36:37]
    s_lshl_b32 s34, s4, 10
    s_add_u32 s34, s34, 1376256
    s_waitcnt vmcnt(0)
    v_lshl_or_b32 v8, v17, 16, v16
    v_lshl_or_b32 v9, v19, 16, v18
    v_lshl_or_b32 v10, v21, 16, v20
    v_lshl_or_b32 v11, v23, 16, v22
    buffer_store_dwordx4 v[8:11], v5, s[8:11], s34 offen
    s_endpgm
P_cs:
    s_sub_u32 s5, s2, 672
    v_and_b32 v2, 15, v0
    v_lshrrev_b32 v3, 4, v0
    v_mul_u32_u24 v3, 28, v3
    v_mov_b32 v16, 0
    v_mov_b32 v17, 0
    v_mov_b32 v18, 0
    v_mov_b32 v19, 0
    v_mov_b32 v20, 0
    v_mov_b32 v21, 0
    v_mov_b32 v22, 0
    v_mov_b32 v23, 0
    v_mov_b32 v24, 0
    v_mov_b32 v25, 0
    v_mov_b32 v26, 0
    v_mov_b32 v27, 0
    v_mov_b32 v28, 0
    v_mov_b32 v29, 0
    v_mov_b32 v30, 0
    v_mov_b32 v31, 0
    v_mov_b32 v32, 0
    v_mov_b32 v33, 0
    v_mov_b32 v34, 0
    v_mov_b32 v35, 0
    v_mov_b32 v36, 0
    v_mov_b32 v37, 0
    v_mov_b32 v38, 0
    v_mov_b32 v39, 0
    v_mov_b32 v40, 0
    v_mov_b32 v41, 0
    v_mov_b32 v42, 0
    v_mov_b32 v43, 0
    s_cmp_ge_u32 s5, 16
    s_cbranch_scc1 P_cs_b
    s_mov_b32 s12, s18
    s_mov_b32 s13, s19
    s_mov_b32 s14, 401408
    s_mov_b32 s15, 0x00020000
    s_mul_i32 s34, s5, 56
    v_mul_u32_u24 v7, 896, v3
    v_lshl_add_u32 v7, v2, 2, v7
    v_add_u32 v7, s34, v7
    s_mov_b32 s38, 0
    v_cmp_gt_u32 vcc, 14, v2
    s_and_saveexec_b64 s[36:37], vcc
    buffer_load_dword v16, v7, s[12:15], s38 offen offset:0
    buffer_load_dword v17, v7, s[12:15], s38 offen offset:896
    buffer_load_dword v18, v7, s[12:15], s38 offen offset:1792
    buffer_load_dword v19, v7, s[12:15], s38 offen offset:2688
    s_add_u32 s38, s38, 3584
    buffer_load_dword v20, v7, s[12:15], s38 offen offset:0
    buffer_load_dword v21, v7, s[12:15], s38 offen offset:896
    buffer_load_dword v22, v7, s[12:15], s38 offen offset:1792
    buffer_load_dword v23, v7, s[12:15], s38 offen offset:2688
    s_add_u32 s38, s38, 3584
    buffer_load_dword v24, v7, s[12:15], s38 offen offset:0
    buffer_load_dword v25, v7, s[12:15], s38 offen offset:896
    buffer_load_dword v26, v7, s[12:15], s38 offen offset:1792
    buffer_load_dword v27, v7, s[12:15], s38 offen offset:2688
    s_add_u32 s38, s38, 3584
    buffer_load_dword v28, v7, s[12:15], s38 offen offset:0
    buffer_load_dword v29, v7, s[12:15], s38 offen offset:896
    buffer_load_dword v30, v7, s[12:15], s38 offen offset:1792
    buffer_load_dword v31, v7, s[12:15], s38 offen offset:2688
    s_add_u32 s38, s38, 3584
    buffer_load_dword v32, v7, s[12:15], s38 offen offset:0
    buffer_load_dword v33, v7, s[12:15], s38 offen offset:896
    buffer_load_dword v34, v7, s[12:15], s38 offen offset:1792
    buffer_load_dword v35, v7, s[12:15], s38 offen offset:2688
    s_add_u32 s38, s38, 3584
    buffer_load_dword v36, v7, s[12:15], s38 offen offset:0
    buffer_load_dword v37, v7, s[12:15], s38 offen offset:896
    buffer_load_dword v38, v7, s[12:15], s38 offen offset:1792
    buffer_load_dword v39, v7, s[12:15], s38 offen offset:2688
    s_add_u32 s38, s38, 3584
    buffer_load_dword v40, v7, s[12:15], s38 offen offset:0
    buffer_load_dword v41, v7, s[12:15], s38 offen offset:896
    buffer_load_dword v42, v7, s[12:15], s38 offen offset:1792
    buffer_load_dword v43, v7, s[12:15], s38 offen offset:2688
    s_add_u32 s38, s38, 3584
    s_andn2_b64 exec, s[36:37], exec
    s_lshl_b32 s35, s5, 7
    s_add_u32 s35, s35, 2752512
    s_and_b32 s34, s5, 7
    s_cmp_eq_u32 s34, 7
    s_cbranch_scc1 P_cs_red
    s_cmp_ge_u32 s5, 8
    s_cbranch_scc1 P_cs_v
    s_mov_b32 s12, s20
    s_mov_b32 s13, s21
    s_lshl_b32 s34, s5, 3
    s_branch P_cs_kv
P_cs_v:
    s_mov_b32 s12, s22
    s_mov_b32 s13, s23
    s_sub_u32 s34, s5, 8
    s_lshl_b32 s34, s34, 3
P_cs_kv:
    s_mov_b32 s14, 25088
    s_mov_b32 s15, 0x00020000
    s_sub_u32 s34, s34, 56
    v_mul_u32_u24 v7, 56, v3
    v_lshl_add_u32 v7, v2, 2, v7
    v_add_u32 v7, s34, v7
    buffer_load_dword v16, v7, s[12:15], 0 offen offset:0
    buffer_load_dword v17, v7, s[12:15], 0 offen offset:56
    buffer_load_dword v18, v7, s[12:15], 0 offen offset:112
    buffer_load_dword v19, v7, s[12:15], 0 offen offset:168
    buffer_load_dword v20, v7, s[12:15], 0 offen offset:224
    buffer_load_dword v21, v7, s[12:15], 0 offen offset:280
    buffer_load_dword v22, v7, s[12:15], 0 offen offset:336
    buffer_load_dword v23, v7, s[12:15], 0 offen offset:392
    buffer_load_dword v24, v7, s[12:15], 0 offen offset:448
    buffer_load_dword v25, v7, s[12:15], 0 offen offset:504
    buffer_load_dword v26, v7, s[12:15], 0 offen offset:560
    buffer_load_dword v27, v7, s[12:15], 0 offen offset:616
    buffer_load_dword v28, v7, s[12:15], 0 offen offset:672
    buffer_load_dword v29, v7, s[12:15], 0 offen offset:728
    buffer_load_dword v30, v7, s[12:15], 0 offen offset:784
    buffer_load_dword v31, v7, s[12:15], 0 offen offset:840
    buffer_load_dword v32, v7, s[12:15], 0 offen offset:896
    buffer_load_dword v33, v7, s[12:15], 0 offen offset:952
    buffer_load_dword v34, v7, s[12:15], 0 offen offset:1008
    buffer_load_dword v35, v7, s[12:15], 0 offen offset:1064
    buffer_load_dword v36, v7, s[12:15], 0 offen offset:1120
    buffer_load_dword v37, v7, s[12:15], 0 offen offset:1176
    buffer_load_dword v38, v7, s[12:15], 0 offen offset:1232
    buffer_load_dword v39, v7, s[12:15], 0 offen offset:1288
    buffer_load_dword v40, v7, s[12:15], 0 offen offset:1344
    buffer_load_dword v41, v7, s[12:15], 0 offen offset:1400
    buffer_load_dword v42, v7, s[12:15], 0 offen offset:1456
    buffer_load_dword v43, v7, s[12:15], 0 offen offset:1512
    s_branch P_cs_red
P_cs_b:
    s_sub_u32 s5, s5, 16
    s_mov_b32 s12, s28
    s_mov_b32 s13, s29
    s_mov_b32 s14, 1204224
    s_mov_b32 s15, 0x00020000
    s_mul_i32 s7, s5, 21846
    s_lshr_b32 s7, s7, 16
    s_mul_i32 s34, s7, 3
    s_sub_u32 s34, s5, s34
    s_mul_i32 s34, s34, 896
    s_mul_i32 s7, s7, 56
    s_add_u32 s34, s34, s7
    s_mov_b32 s7, 2688
    v_mul_lo_u32 v7, s7, v3
    v_lshl_add_u32 v7, v2, 2, v7
    v_add_u32 v7, s34, v7
    s_lshl_b32 s35, s5, 7
    s_add_u32 s35, s35, 2756608
    s_mov_b32 s38, 0
    v_cmp_gt_u32 vcc, 14, v2
    s_and_saveexec_b64 s[36:37], vcc
    buffer_load_dword v16, v7, s[12:15], s38 offen offset:0
    buffer_load_dword v17, v7, s[12:15], s38 offen offset:2688
    s_add_u32 s38, s38, 5376
    buffer_load_dword v18, v7, s[12:15], s38 offen offset:0
    buffer_load_dword v19, v7, s[12:15], s38 offen offset:2688
    s_add_u32 s38, s38, 5376
    buffer_load_dword v20, v7, s[12:15], s38 offen offset:0
    buffer_load_dword v21, v7, s[12:15], s38 offen offset:2688
    s_add_u32 s38, s38, 5376
    buffer_load_dword v22, v7, s[12:15], s38 offen offset:0
    buffer_load_dword v23, v7, s[12:15], s38 offen offset:2688
    s_add_u32 s38, s38, 5376
    buffer_load_dword v24, v7, s[12:15], s38 offen offset:0
    buffer_load_dword v25, v7, s[12:15], s38 offen offset:2688
    s_add_u32 s38, s38, 5376
    buffer_load_dword v26, v7, s[12:15], s38 offen offset:0
    buffer_load_dword v27, v7, s[12:15], s38 offen offset:2688
    s_add_u32 s38, s38, 5376
    buffer_load_dword v28, v7, s[12:15], s38 offen offset:0
    buffer_load_dword v29, v7, s[12:15], s38 offen offset:2688
    s_add_u32 s38, s38, 5376
    buffer_load_dword v30, v7, s[12:15], s38 offen offset:0
    buffer_load_dword v31, v7, s[12:15], s38 offen offset:2688
    s_add_u32 s38, s38, 5376
    buffer_load_dword v32, v7, s[12:15], s38 offen offset:0
    buffer_load_dword v33, v7, s[12:15], s38 offen offset:2688
    s_add_u32 s38, s38, 5376
    buffer_load_dword v34, v7, s[12:15], s38 offen offset:0
    buffer_load_dword v35, v7, s[12:15], s38 offen offset:2688
    s_add_u32 s38, s38, 5376
    buffer_load_dword v36, v7, s[12:15], s38 offen offset:0
    buffer_load_dword v37, v7, s[12:15], s38 offen offset:2688
    s_add_u32 s38, s38, 5376
    buffer_load_dword v38, v7, s[12:15], s38 offen offset:0
    buffer_load_dword v39, v7, s[12:15], s38 offen offset:2688
    s_add_u32 s38, s38, 5376
    buffer_load_dword v40, v7, s[12:15], s38 offen offset:0
    buffer_load_dword v41, v7, s[12:15], s38 offen offset:2688
    s_add_u32 s38, s38, 5376
    buffer_load_dword v42, v7, s[12:15], s38 offen offset:0
    buffer_load_dword v43, v7, s[12:15], s38 offen offset:2688
    s_add_u32 s38, s38, 5376
P_cs_red:
    s_mov_b64 exec, s[36:37]
    v_mov_b32 v8, 0
    v_mov_b32 v9, 0
    s_waitcnt vmcnt(0)
    s_movk_i32 s38, 0x3f80
    s_mov_b32 s39, 0x3f800000
    v_dot2_f32_bf16 v8, v16, s38, v8
    v_dot2_f32_bf16 v9, v16, s39, v9
    v_dot2_f32_bf16 v8, v17, s38, v8
    v_dot2_f32_bf16 v9, v17, s39, v9
    v_dot2_f32_bf16 v8, v18, s38, v8
    v_dot2_f32_bf16 v9, v18, s39, v9
    v_dot2_f32_bf16 v8, v19, s38, v8
    v_dot2_f32_bf16 v9, v19, s39, v9
    v_dot2_f32_bf16 v8, v20, s38, v8
    v_dot2_f32_bf16 v9, v20, s39, v9
    v_dot2_f32_bf16 v8, v21, s38, v8
    v_dot2_f32_bf16 v9, v21, s39, v9
    v_dot2_f32_bf16 v8, v22, s38, v8
    v_dot2_f32_bf16 v9, v22, s39, v9
    v_dot2_f32_bf16 v8, v23, s38, v8
    v_dot2_f32_bf16 v9, v23, s39, v9
    v_dot2_f32_bf16 v8, v24, s38, v8
    v_dot2_f32_bf16 v9, v24, s39, v9
    v_dot2_f32_bf16 v8, v25, s38, v8
    v_dot2_f32_bf16 v9, v25, s39, v9
    v_dot2_f32_bf16 v8, v26, s38, v8
    v_dot2_f32_bf16 v9, v26, s39, v9
    v_dot2_f32_bf16 v8, v27, s38, v8
    v_dot2_f32_bf16 v9, v27, s39, v9
    v_dot2_f32_bf16 v8, v28, s38, v8
    v_dot2_f32_bf16 v9, v28, s39, v9
    v_dot2_f32_bf16 v8, v29, s38, v8
    v_dot2_f32_bf16 v9, v29, s39, v9
    v_dot2_f32_bf16 v8, v30, s38, v8
    v_dot2_f32_bf16 v9, v30, s39, v9
    v_dot2_f32_bf16 v8, v31, s38, v8
    v_dot2_f32_bf16 v9, v31, s39, v9
    v_dot2_f32_bf16 v8, v32, s38, v8
    v_dot2_f32_bf16 v9, v32, s39, v9
    v_dot2_f32_bf16 v8, v33, s38, v8
    v_dot2_f32_bf16 v9, v33, s39, v9
    v_dot2_f32_bf16 v8, v34, s38, v8
    v_dot2_f32_bf16 v9, v34, s39, v9
    v_dot2_f32_bf16 v8, v35, s38, v8
    v_dot2_f32_bf16 v9, v35, s39, v9
    v_dot2_f32_bf16 v8, v36, s38, v8
    v_dot2_f32_bf16 v9, v36, s39, v9
    v_dot2_f32_bf16 v8, v37, s38, v8
    v_dot2_f32_bf16 v9, v37, s39, v9
    v_dot2_f32_bf16 v8, v38, s38, v8
    v_dot2_f32_bf16 v9, v38, s39, v9
    v_dot2_f32_bf16 v8, v39, s38, v8
    v_dot2_f32_bf16 v9, v39, s39, v9
    v_dot2_f32_bf16 v8, v40, s38, v8
    v_dot2_f32_bf16 v9, v40, s39, v9
    v_dot2_f32_bf16 v8, v41, s38, v8
    v_dot2_f32_bf16 v9, v41, s39, v9
    v_dot2_f32_bf16 v8, v42, s38, v8
    v_dot2_f32_bf16 v9, v42, s39, v9
    v_dot2_f32_bf16 v8, v43, s38, v8
    v_dot2_f32_bf16 v9, v43, s39, v9
    s_nop 2
    v_lshlrev_b32 v6, 3, v0
    ds_write_b64 v6, v[8:9]
    s_waitcnt lgkmcnt(0)
    s_barrier
    v_cmp_gt_u32 vcc, 32, v0
    s_and_saveexec_b64 s[36:37], vcc
    s_cbranch_execz P_done
    v_lshlrev_b32 v6, 2, v0
    ds_read_b32 v16, v6 offset:0
    ds_read_b32 v17, v6 offset:128
    ds_read_b32 v18, v6 offset:256
    ds_read_b32 v19, v6 offset:384
    ds_read_b32 v20, v6 offset:512
    ds_read_b32 v21, v6 offset:640
    ds_read_b32 v22, v6 offset:768
    ds_read_b32 v23, v6 offset:896
    ds_read_b32 v24, v6 offset:1024
    ds_read_b32 v25, v6 offset:1152
    ds_read_b32 v26, v6 offset:1280
    ds_read_b32 v27, v6 offset:1408
    ds_read_b32 v28, v6 offset:1536
    ds_read_b32 v29, v6 offset:1664
    ds_read_b32 v30, v6 offset:1792
    ds_read_b32 v31, v6 offset:1920
    s_waitcnt lgkmcnt(0)
    v_add_f32 v16, v16, v17
    v_add_f32 v16, v16, v18
    v_add_f32 v16, v16, v19
    v_add_f32 v16, v16, v20
    v_add_f32 v16, v16, v21
    v_add_f32 v16, v16, v22
    v_add_f32 v16, v16, v23
    v_add_f32 v16, v16, v24
    v_add_f32 v16, v16, v25
    v_add_f32 v16, v16, v26
    v_add_f32 v16, v16, v27
    v_add_f32 v16, v16, v28
    v_add_f32 v16, v16, v29
    v_add_f32 v16, v16, v30
    v_add_f32 v16, v16, v31
    buffer_store_dword v16, v6, s[8:11], s35 offen
    s_endpgm
P_x0:
    s_sub_u32 s4, s4, 3200
    s_mul_i32 s5, s4, 4682
    s_lshr_b32 s5, s5, 16
    s_mul_i32 s6, s5, 14
    s_sub_u32 s6, s4, s6
    s_mov_b32 s12, s16
    s_mov_b32 s13, s17
    s_mov_b32 s14, 1835008
    s_mov_b32 s15, 0x00020000
    s_lshl_b32 s7, s5, 5
    v_add_u32 v6, s7, v2
    v_mul_u32_u24 v7, 896, v6
    v_lshl_add_u32 v7, v3, 3, v7
    s_lshl_b32 s7, s6, 6
    buffer_load_dwordx2 v[16:17], v7, s[12:15], s7 offen
    buffer_load_dwordx2 v[18:19], v7, s[12:15], s7 offen offset:16
    buffer_load_dwordx2 v[20:21], v7, s[12:15], s7 offen offset:32
    buffer_load_dwordx2 v[22:23], v7, s[12:15], s7 offen offset:48
    s_lshl_b32 s34, s4, 11
    s_add_u32 s34, s34, 5976064
    s_waitcnt vmcnt(2)
    buffer_store_dwordx4 v[16:19], v5, s[8:11], s34 offen
    s_waitcnt vmcnt(1)
    buffer_store_dwordx4 v[20:23], v5, s[8:11], s34 offen offset:1024
    s_endpgm
P_st:
    s_sub_u32 s4, s4, 2944
    s_mov_b32 s12, s16
    s_mov_b32 s13, s17
    s_mov_b32 s14, 1835008
    s_mov_b32 s15, 0x00020000
    v_lshrrev_b32 v6, 3, v1
    v_and_b32 v7, 7, v1
    s_lshl_b32 s5, s4, 3
    v_add_u32 v12, s5, v6
    v_mul_u32_u24 v12, 896, v12
    v_lshl_add_u32 v12, v7, 4, v12
    buffer_load_dwordx4 v[16:19], v12, s[12:15], 0 offen offset:0
    buffer_load_dwordx4 v[20:23], v12, s[12:15], 0 offen offset:128
    buffer_load_dwordx4 v[24:27], v12, s[12:15], 0 offen offset:256
    buffer_load_dwordx4 v[28:31], v12, s[12:15], 0 offen offset:384
    buffer_load_dwordx4 v[32:35], v12, s[12:15], 0 offen offset:512
    buffer_load_dwordx4 v[36:39], v12, s[12:15], 0 offen offset:640
    buffer_load_dwordx4 v[40:43], v12, s[12:15], 0 offen offset:768
    s_mov_b32 s38, 0x3f803f80
    s_lshr_b32 s34, s4, 2
    s_lshl_b32 s34, s34, 12
    s_and_b32 s35, s4, 3
    s_lshl_b32 s35, s35, 6
    s_add_u32 s34, s34, s35
    s_add_u32 s34, s34, 2764800
    v_lshlrev_b32 v13, 3, v6
    v_lshl_add_u32 v13, v7, 8, v13
    v_cmp_eq_u32 vcc, 0, v7
    v_mov_b32 v10, 0
    v_mov_b32 v11, 0
    s_waitcnt vmcnt(6)
    v_dot2_f32_bf16 v8, v16, s38, v8
    v_dot2_f32_bf16 v9, v16, v16, v9
    v_dot2_f32_bf16 v8, v17, s38, v8
    v_dot2_f32_bf16 v9, v17, v17, v9
    v_dot2_f32_bf16 v8, v18, s38, v8
    v_dot2_f32_bf16 v9, v18, v18, v9
    v_dot2_f32_bf16 v8, v19, s38, v8
    v_dot2_f32_bf16 v9, v19, v19, v9
    s_waitcnt vmcnt(5)
    v_dot2_f32_bf16 v8, v20, s38, v8
    v_dot2_f32_bf16 v9, v20, v20, v9
    v_dot2_f32_bf16 v8, v21, s38, v8
    v_dot2_f32_bf16 v9, v21, v21, v9
    v_dot2_f32_bf16 v8, v22, s38, v8
    v_dot2_f32_bf16 v9, v22, v22, v9
    v_dot2_f32_bf16 v8, v23, s38, v8
    v_dot2_f32_bf16 v9, v23, v23, v9
    s_waitcnt vmcnt(4)
    v_dot2_f32_bf16 v8, v24, s38, v8
    v_dot2_f32_bf16 v9, v24, v24, v9
    v_dot2_f32_bf16 v8, v25, s38, v8
    v_dot2_f32_bf16 v9, v25, v25, v9
    v_dot2_f32_bf16 v8, v26, s38, v8
    v_dot2_f32_bf16 v9, v26, v26, v9
    v_dot2_f32_bf16 v8, v27, s38, v8
    v_dot2_f32_bf16 v9, v27, v27, v9
    s_waitcnt vmcnt(3)
    v_dot2_f32_bf16 v8, v28, s38, v8
    v_dot2_f32_bf16 v9, v28, v28, v9
    v_dot2_f32_bf16 v8, v29, s38, v8
    v_dot2_f32_bf16 v9, v29, v29, v9
    v_dot2_f32_bf16 v8, v30, s38, v8
    v_dot2_f32_bf16 v9, v30, v30, v9
    v_dot2_f32_bf16 v8, v31, s38, v8
    v_dot2_f32_bf16 v9, v31, v31, v9
    s_waitcnt vmcnt(2)
    v_dot2_f32_bf16 v8, v32, s38, v8
    v_dot2_f32_bf16 v9, v32, v32, v9
    v_dot2_f32_bf16 v8, v33, s38, v8
    v_dot2_f32_bf16 v9, v33, v33, v9
    v_dot2_f32_bf16 v8, v34, s38, v8
    v_dot2_f32_bf16 v9, v34, v34, v9
    v_dot2_f32_bf16 v8, v35, s38, v8
    v_dot2_f32_bf16 v9, v35, v35, v9
    s_waitcnt vmcnt(1)
    v_dot2_f32_bf16 v8, v36, s38, v8
    v_dot2_f32_bf16 v9, v36, v36, v9
    v_dot2_f32_bf16 v8, v37, s38, v8
    v_dot2_f32_bf16 v9, v37, v37, v9
    v_dot2_f32_bf16 v8, v38, s38, v8
    v_dot2_f32_bf16 v9, v38, v38, v9
    v_dot2_f32_bf16 v8, v39, s38, v8
    v_dot2_f32_bf16 v9, v39, v39, v9
    s_waitcnt vmcnt(0)
    v_dot2_f32_bf16 v8, v40, s38, v8
    v_dot2_f32_bf16 v9, v40, v40, v9
    v_dot2_f32_bf16 v8, v41, s38, v8
    v_dot2_f32_bf16 v9, v41, v41, v9
    v_dot2_f32_bf16 v8, v42, s38, v8
    v_dot2_f32_bf16 v9, v42, v42, v9
    v_dot2_f32_bf16 v8, v43, s38, v8
    v_dot2_f32_bf16 v9, v43, v43, v9
    s_nop 2
    v_add_f32_dpp v8, v8, v8 quad_perm:[1,0,3,2] row_mask:0xf bank_mask:0xf
    v_add_f32_dpp v9, v9, v9 quad_perm:[1,0,3,2] row_mask:0xf bank_mask:0xf
    s_nop 0
    v_add_f32_dpp v8, v8, v8 quad_perm:[2,3,0,1] row_mask:0xf bank_mask:0xf
    v_add_f32_dpp v9, v9, v9 quad_perm:[2,3,0,1] row_mask:0xf bank_mask:0xf
    s_nop 0
    v_add_f32_dpp v8, v8, v8 row_half_mirror row_mask:0xf bank_mask:0xf
    v_add_f32_dpp v9, v9, v9 row_half_mirror row_mask:0xf bank_mask:0xf
    s_nop 0
    v_cndmask_b32 v8, 0, v8, vcc
    v_cndmask_b32 v9, 0, v9, vcc
    buffer_store_dwordx2 v[8:9], v13, s[8:11], s34 offen
    buffer_store_dwordx2 v[10:11], v13, s[8:11], s34 offen offset:2048
    s_endpgm
P_fill:
    v_mov_b32 v8, -1
    v_mov_b32 v9, -1
    v_mov_b32 v10, -1
    v_mov_b32 v11, -1
    v_lshlrev_b32 v6, 4, v0
    s_lshl_b32 s34, s2, 14
    s_add_u32 s35, s34, 15085568
    s_add_u32 s34, s34, 3026944
    s_cmp_lt_u32 s2, 180
    s_cselect_b32 s34, s34, s35
    s_mov_b32 s35, 19148800
    s_cselect_b32 s10, 5976064, s35
    buffer_store_dwordx4 v[8:11], v6, s[8:11], s34 offen
    s_add_u32 s34, s34, 4096
    buffer_store_dwordx4 v[8:11], v6, s[8:11], s34 offen
    s_add_u32 s34, s34, 4096
    buffer_store_dwordx4 v[8:11], v6, s[8:11], s34 offen
    s_add_u32 s34, s34, 4096
    buffer_store_dwordx4 v[8:11], v6, s[8:11], s34 offen
    s_add_u32 s34, s34, 4096
    s_endpgm
P_done:
    s_endpgm
.globl main_kernel
.p2align 8
.type main_kernel,@function
main_kernel:
    s_cmp_ge_u32 s2, 256
    s_cbranch_scc1 M_done
    s_getpc_b64 s[60:61]
M_pc:
    s_lshr_b32 s20, s2, 3
    s_and_b32 s20, s20, 7
    s_lshl_b32 s20, s20, 12
    s_min_u32 s20, s20, M_done-M_pc-4096
    v_lshlrev_b32 v4, 4, v0
    v_add_u32 v4, s20, v4
    global_load_dwordx4 v[8:11], v4, s[60:61]
    s_load_dwordx2 s[16:17], s[0:1], 80
    s_load_dwordx2 s[18:19], s[0:1], 64
    v_lshrrev_b32 v4, 6, v0
    v_and_b32 v1, 63, v0
    v_and_b32 v2, 31, v0
    v_readfirstlane_b32 s3, v4
    v_bfe_u32 v3, v0, 5, 1
    v_lshlrev_b32 v1, 4, v1
    s_lshr_b32 s4, s2, 4
    s_and_b32 s5, s2, 15
    s_lshl_b32 s6, s4, 2
    s_and_b32 s31, s5, 3
    s_add_u32 s31, s31, s6
    s_add_u32 s6, s6, s3
    s_lshl_b32 s7, s4, 4
    s_add_u32 s7, s7, s5
    s_and_b32 s32, s5, 12
    s_add_u32 s32, s32, s3
    s_min_u32 s36, s32, 13
    s_mov_b32 s30, 2764800
    s_mov_b32 s33, 0
    s_mov_b32 s54, 0xfffffffe
    s_waitcnt lgkmcnt(0)
    s_mov_b32 s8, s16
    s_mov_b32 s9, s17
    s_mov_b32 s10, 48574464
    s_mov_b32 s11, 0x00020000
    s_mov_b32 s12, s18
    s_mov_b32 s13, s19
    s_mov_b32 s14, 1835008
    s_mov_b32 s15, 0x00020000
    v_lshrrev_b32 v4, 3, v2
    v_and_b32 v5, 7, v2
    v_lshlrev_b32 v5, 4, v5
    v_lshl_add_u32 v5, v3, 9, v5
    v_lshl_add_u32 v236, v4, 13, v5
    v_lshl_add_u32 v237, v4, 11, v5
    s_mul_i32 s21, s31, 28672
    s_mul_i32 s22, s3, 7168
    s_add_u32 s21, s21, s22
    s_add_u32 s27, s21, 5976064
    s_add_u32 s22, s22, 86016
    s_mov_b32 m0, s22
    s_nop 0
    buffer_load_dwordx4 v1, s[8:11], s27 offen offset:0 lds
    buffer_load_dwordx4 v1, s[8:11], s27 offen offset:1024 lds
    buffer_load_dwordx4 v1, s[8:11], s27 offen offset:2048 lds
    buffer_load_dwordx4 v1, s[8:11], s27 offen offset:3072 lds
    s_add_u32 s29, s27, 4096
    s_add_u32 s25, s22, 4096
    s_mov_b32 m0, s25
    s_nop 0
    buffer_load_dwordx4 v1, s[8:11], s29 offen offset:0 lds
    buffer_load_dwordx4 v1, s[8:11], s29 offen offset:1024 lds
    buffer_load_dwordx4 v1, s[8:11], s29 offen offset:2048 lds
    v_mul_u32_u24 v176, 1792, v3
    v_lshl_add_u32 v176, v2, 3, v176
    s_lshl_b32 s20, s31, 12
    s_add_u32 s20, s20, 2764800
    buffer_load_dwordx2 v[160:161], v176, s[8:11], s20 offen offset:0
    buffer_load_dwordx2 v[162:163], v176, s[8:11], s20 offen offset:256
    buffer_load_dwordx2 v[164:165], v176, s[8:11], s20 offen offset:512
    buffer_load_dwordx2 v[166:167], v176, s[8:11], s20 offen offset:768
    buffer_load_dwordx2 v[168:169], v176, s[8:11], s20 offen offset:1024
    buffer_load_dwordx2 v[170:171], v176, s[8:11], s20 offen offset:1280
    buffer_load_dwordx2 v[172:173], v176, s[8:11], s20 offen offset:1536
    s_mul_i32 s20, s32, 28672
    s_add_u32 s20, s20, 0
    buffer_load_dwordx4 a[0:3], v1, s[8:11], s20 offen offset:0
    buffer_load_dwordx4 a[4:7], v1, s[8:11], s20 offen offset:1024
    buffer_load_dwordx4 a[8:11], v1, s[8:11], s20 offen offset:2048
    buffer_load_dwordx4 a[12:15], v1, s[8:11], s20 offen offset:3072
    s_add_u32 s29, s20, 4096
    buffer_load_dwordx4 a[16:19], v1, s[8:11], s29 offen offset:0
    buffer_load_dwordx4 a[20:23], v1, s[8:11], s29 offen offset:1024
    buffer_load_dwordx4 a[24:27], v1, s[8:11], s29 offen offset:2048
    buffer_load_dwordx4 a[28:31], v1, s[8:11], s29 offen offset:3072
    s_add_u32 s29, s20, 8192
    buffer_load_dwordx4 a[32:35], v1, s[8:11], s29 offen offset:0
    buffer_load_dwordx4 a[36:39], v1, s[8:11], s29 offen offset:1024
    buffer_load_dwordx4 a[40:43], v1, s[8:11], s29 offen offset:2048
    buffer_load_dwordx4 a[44:47], v1, s[8:11], s29 offen offset:3072
    s_add_u32 s29, s20, 12288
    buffer_load_dwordx4 a[48:51], v1, s[8:11], s29 offen offset:0
    buffer_load_dwordx4 a[52:55], v1, s[8:11], s29 offen offset:1024
    buffer_load_dwordx4 a[56:59], v1, s[8:11], s29 offen offset:2048
    buffer_load_dwordx4 a[60:63], v1, s[8:11], s29 offen offset:3072
    s_add_u32 s29, s20, 16384
    buffer_load_dwordx4 a[64:67], v1, s[8:11], s29 offen offset:0
    buffer_load_dwordx4 a[68:71], v1, s[8:11], s29 offen offset:1024
    buffer_load_dwordx4 a[72:75], v1, s[8:11], s29 offen offset:2048
    buffer_load_dwordx4 a[76:79], v1, s[8:11], s29 offen offset:3072
    s_add_u32 s29, s20, 20480
    buffer_load_dwordx4 a[80:83], v1, s[8:11], s29 offen offset:0
    buffer_load_dwordx4 a[84:87], v1, s[8:11], s29 offen offset:1024
    buffer_load_dwordx4 a[88:91], v1, s[8:11], s29 offen offset:2048
    buffer_load_dwordx4 a[92:95], v1, s[8:11], s29 offen offset:3072
    s_add_u32 s29, s20, 24576
    buffer_load_dwordx4 a[96:99], v1, s[8:11], s29 offen offset:0
    buffer_load_dwordx4 a[100:103], v1, s[8:11], s29 offen offset:1024
    buffer_load_dwordx4 a[104:107], v1, s[8:11], s29 offen offset:2048
    buffer_load_dwordx4 a[108:111], v1, s[8:11], s29 offen offset:3072
    s_lshl_b32 s20, s32, 7
    s_add_u32 s20, s20, 2752512
    v_lshlrev_b32 v177, 4, v3
    buffer_load_dwordx4 v[144:147], v177, s[8:11], s20 offen offset:0
    buffer_load_dwordx4 v[148:151], v177, s[8:11], s20 offen offset:32
    buffer_load_dwordx4 v[152:155], v177, s[8:11], s20 offen offset:64
    buffer_load_dwordx4 v[156:159], v177, s[8:11], s20 offen offset:96
    s_mul_i32 s20, s31, 28672
    s_lshl_b32 s23, s36, 11
    s_add_u32 s20, s20, s23
    s_add_u32 s20, s20, 5976064
    buffer_load_dwordx4 v[240:243], v1, s[8:11], s20 offen
    buffer_load_dwordx4 v[244:247], v1, s[8:11], s20 offen offset:1024
    s_waitcnt vmcnt(34)
    s_branch M_qa_entry
M_pair:
    s_barrier
    s_lshl_b32 s21, s32, 7
    s_add_u32 s21, s21, 2752512
    v_lshlrev_b32 v177, 4, v3
    buffer_load_dwordx4 v[144:147], v177, s[8:11], s21 offen offset:0
    buffer_load_dwordx4 v[148:151], v177, s[8:11], s21 offen offset:32
    buffer_load_dwordx4 v[152:155], v177, s[8:11], s21 offen offset:64
    buffer_load_dwordx4 v[156:159], v177, s[8:11], s21 offen offset:96
    v_mul_u32_u24 v176, 1792, v3
    v_lshl_add_u32 v176, v2, 3, v176
    s_lshl_b32 s20, s31, 12
    s_add_u32 s20, s20, s30
    s_add_u32 s20, s20, 0
    s_mov_b32 s35, 0
L_st_1:
    buffer_load_dwordx2 v[160:161], v176, s[8:11], s20 offen offset:0 sc1
    buffer_load_dwordx2 v[162:163], v176, s[8:11], s20 offen offset:256 sc1
    buffer_load_dwordx2 v[164:165], v176, s[8:11], s20 offen offset:512 sc1
    buffer_load_dwordx2 v[166:167], v176, s[8:11], s20 offen offset:768 sc1
    buffer_load_dwordx2 v[168:169], v176, s[8:11], s20 offen offset:1024 sc1
    buffer_load_dwordx2 v[170:171], v176, s[8:11], s20 offen offset:1280 sc1
    buffer_load_dwordx2 v[172:173], v176, s[8:11], s20 offen offset:1536 sc1
    s_waitcnt vmcnt(0)
    v_max3_u32 v178, v160, v161, v162
    v_max3_u32 v178, v178, v163, v164
    v_max3_u32 v178, v178, v165, v166
    v_max3_u32 v178, v178, v167, v168
    v_max3_u32 v178, v178, v169, v170
    v_max3_u32 v178, v178, v171, v172
    v_max_u32 v178, v178, v173
    v_cmp_eq_u32 vcc, -1, v178
    s_nop 1
    s_cmp_lg_u64 vcc, 0
    s_cbranch_scc1 L_st_r_2
L_st_ok_3:
    s_mul_i32 s21, s31, 28672
    s_mul_i32 s22, s3, 7168
    s_add_u32 s21, s21, s22
    s_add_u32 s21, s21, s30
    s_add_u32 s27, s21, 3211264
    s_add_u32 s22, s22, 86016
    s_mov_b32 m0, s22
    s_nop 0
    buffer_load_dwordx4 v1, s[8:11], s27 offen offset:0 lds
    buffer_load_dwordx4 v1, s[8:11], s27 offen offset:1024 lds
    buffer_load_dwordx4 v1, s[8:11], s27 offen offset:2048 lds
    buffer_load_dwordx4 v1, s[8:11], s27 offen offset:3072 lds
    s_add_u32 s29, s27, 4096
    s_add_u32 s25, s22, 4096
    s_mov_b32 m0, s25
    s_nop 0
    buffer_load_dwordx4 v1, s[8:11], s29 offen offset:0 lds
    buffer_load_dwordx4 v1, s[8:11], s29 offen offset:1024 lds
    buffer_load_dwordx4 v1, s[8:11], s29 offen offset:2048 lds
M_qa_entry:
    v_add_f32 v160, v160, v162
    v_add_f32 v161, v161, v163
    v_add_f32 v160, v160, v164
    v_add_f32 v161, v161, v165
    v_add_f32 v160, v160, v166
    v_add_f32 v161, v161, v167
    v_add_f32 v160, v160, v168
    v_add_f32 v161, v161, v169
    v_add_f32 v160, v160, v170
    v_add_f32 v161, v161, v171
    v_add_f32 v160, v160, v172
    v_add_f32 v161, v161, v173
    v_mov_b32 v176, v160
    v_mov_b32 v177, v161
    s_nop 1
    v_permlane32_swap_b32 v160, v176
    v_permlane32_swap_b32 v161, v177
    s_nop 1
    v_add_f32 v160, v160, v176
    v_add_f32 v161, v161, v177
    v_mul_f32 v174, 0xbb124925, v160
    v_mul_f32 v176, 0x3b124925, v161
    v_fma_f32 v176, -v174, v174, v176
    v_max_f32 v176, 0, v176
    v_add_f32 v176, 0x3727c5ac, v176
    v_rsq_f32 v175, v176
    s_nop 0
    v_add_u32 v181, s22, v1
    v_add_u32 v179, 86016, v1
    v_mul_f32 v176, 0x3e8b97f6, v175
    s_mov_b32 s53, 0
    s_cmp_eq_u32 s33, 0
    s_cbranch_scc1 L_qa_mm_4_b
    s_waitcnt vmcnt(0)
L_qa_mm_4_b:
    s_barrier
L_qa_mm_4:
    v_cmp_eq_u32 vcc, 1, v3
    ds_read_b128 v[16:19], v179 offset:0
    ds_read_b128 v[20:23], v179 offset:1024
    ds_read_b128 v[24:27], v179 offset:2048
    ds_read_b128 v[28:31], v179 offset:3072
    ds_read_b128 v[32:35], v179 offset:4096
    ds_read_b128 v[36:39], v179 offset:5120
    ds_read_b128 v[40:43], v179 offset:6144
    ds_read_b128 v[44:47], v179 offset:7168
    ds_read_b128 v[48:51], v179 offset:8192
    ds_read_b128 v[52:55], v179 offset:9216
    ds_read_b128 v[56:59], v179 offset:10240
    ds_read_b128 v[60:63], v179 offset:11264
    ds_read_b128 v[64:67], v179 offset:12288
    ds_read_b128 v[68:71], v179 offset:13312
    ds_read_b128 v[72:75], v179 offset:14336
    ds_read_b128 v[76:79], v179 offset:15360
    ds_read_b128 v[80:83], v179 offset:16384
    ds_read_b128 v[84:87], v179 offset:17408
    ds_read_b128 v[88:91], v179 offset:18432
    ds_read_b128 v[92:95], v179 offset:19456
    ds_read_b128 v[96:99], v179 offset:20480
    ds_read_b128 v[100:103], v179 offset:21504
    ds_read_b128 v[104:107], v179 offset:22528
    ds_read_b128 v[108:111], v179 offset:23552
    ds_read_b128 v[112:115], v179 offset:24576
    ds_read_b128 v[116:119], v179 offset:25600
    ds_read_b128 v[120:123], v179 offset:26624
    ds_read_b128 v[124:127], v179 offset:27648
    v_cndmask_b32 v177, v176, v175, vcc
    s_waitcnt vmcnt(33) lgkmcnt(15)
    v_mfma_f32_32x32x16_bf16 v[128:143], a[0:3], v[16:19], 0
    s_waitcnt vmcnt(32) lgkmcnt(15)
    v_mfma_f32_32x32x16_bf16 v[128:143], a[4:7], v[20:23], v[128:143]
    s_waitcnt vmcnt(31) lgkmcnt(15)
    v_mfma_f32_32x32x16_bf16 v[128:143], a[8:11], v[24:27], v[128:143]
    s_waitcnt vmcnt(30) lgkmcnt(15)
    v_mfma_f32_32x32x16_bf16 v[128:143], a[12:15], v[28:31], v[128:143]
    s_waitcnt vmcnt(29) lgkmcnt(15)
    v_mfma_f32_32x32x16_bf16 v[128:143], a[16:19], v[32:35], v[128:143]
    s_waitcnt vmcnt(28) lgkmcnt(15)
    v_mfma_f32_32x32x16_bf16 v[128:143], a[20:23], v[36:39], v[128:143]
    s_waitcnt vmcnt(27) lgkmcnt(15)
    v_mfma_f32_32x32x16_bf16 v[128:143], a[24:27], v[40:43], v[128:143]
    s_waitcnt vmcnt(26) lgkmcnt(15)
    v_mfma_f32_32x32x16_bf16 v[128:143], a[28:31], v[44:47], v[128:143]
    s_waitcnt vmcnt(25) lgkmcnt(15)
    v_mfma_f32_32x32x16_bf16 v[128:143], a[32:35], v[48:51], v[128:143]
    s_waitcnt vmcnt(24) lgkmcnt(15)
    v_mfma_f32_32x32x16_bf16 v[128:143], a[36:39], v[52:55], v[128:143]
    s_waitcnt vmcnt(23) lgkmcnt(15)
    v_mfma_f32_32x32x16_bf16 v[128:143], a[40:43], v[56:59], v[128:143]
    s_waitcnt vmcnt(22) lgkmcnt(15)
    v_mfma_f32_32x32x16_bf16 v[128:143], a[44:47], v[60:63], v[128:143]
    s_waitcnt vmcnt(21) lgkmcnt(15)
    v_mfma_f32_32x32x16_bf16 v[128:143], a[48:51], v[64:67], v[128:143]
    s_waitcnt vmcnt(20) lgkmcnt(14)
    v_mfma_f32_32x32x16_bf16 v[128:143], a[52:55], v[68:71], v[128:143]
    s_waitcnt vmcnt(19) lgkmcnt(13)
    v_mfma_f32_32x32x16_bf16 v[128:143], a[56:59], v[72:75], v[128:143]
    s_waitcnt vmcnt(18) lgkmcnt(12)
    v_mfma_f32_32x32x16_bf16 v[128:143], a[60:63], v[76:79], v[128:143]
    s_waitcnt vmcnt(17) lgkmcnt(11)
    v_mfma_f32_32x32x16_bf16 v[128:143], a[64:67], v[80:83], v[128:143]
    s_waitcnt vmcnt(16) lgkmcnt(10)
    v_mfma_f32_32x32x16_bf16 v[128:143], a[68:71], v[84:87], v[128:143]
    s_waitcnt vmcnt(15) lgkmcnt(9)
    v_mfma_f32_32x32x16_bf16 v[128:143], a[72:75], v[88:91], v[128:143]
    s_waitcnt vmcnt(14) lgkmcnt(8)
    v_mfma_f32_32x32x16_bf16 v[128:143], a[76:79], v[92:95], v[128:143]
    s_waitcnt vmcnt(13) lgkmcnt(7)
    v_mfma_f32_32x32x16_bf16 v[128:143], a[80:83], v[96:99], v[128:143]
    s_waitcnt vmcnt(12) lgkmcnt(6)
    v_mfma_f32_32x32x16_bf16 v[128:143], a[84:87], v[100:103], v[128:143]
    s_waitcnt vmcnt(11) lgkmcnt(5)
    v_mfma_f32_32x32x16_bf16 v[128:143], a[88:91], v[104:107], v[128:143]
    s_waitcnt vmcnt(10) lgkmcnt(4)
    v_mfma_f32_32x32x16_bf16 v[128:143], a[92:95], v[108:111], v[128:143]
    s_waitcnt vmcnt(9) lgkmcnt(3)
    v_mfma_f32_32x32x16_bf16 v[128:143], a[96:99], v[112:115], v[128:143]
    s_waitcnt vmcnt(8) lgkmcnt(2)
    v_mfma_f32_32x32x16_bf16 v[128:143], a[100:103], v[116:119], v[128:143]
    s_waitcnt vmcnt(7) lgkmcnt(1)
    v_mfma_f32_32x32x16_bf16 v[128:143], a[104:107], v[120:123], v[128:143]
    s_waitcnt vmcnt(6) lgkmcnt(0)
    v_mfma_f32_32x32x16_bf16 v[128:143], a[108:111], v[124:127], v[128:143]
    s_waitcnt vmcnt(0)
    s_and_b32 s21, s3, 1
    s_lshl_b32 s21, s21, 9
    s_lshr_b32 s22, s3, 1
    s_lshl_b32 s22, s22, 3
    s_add_u32 s21, s21, s22
    s_add_u32 s21, s21, 155648
    v_lshl_add_u32 v200, v2, 4, s21
    v_lshrrev_b32 v201, 4, v2
    v_lshlrev_b32 v201, 9, v201
    v_bfe_u32 v202, v2, 2, 1
    v_lshl_add_u32 v201, v202, 8, v201
    v_bfe_u32 v202, v2, 3, 1
    v_lshl_add_u32 v201, v202, 3, v201
    v_and_b32 v202, 3, v2
    v_lshl_add_u32 v201, v202, 1, v201
    s_lshl_b32 s21, s3, 6
    s_add_u32 s21, s21, 155648
    v_add_u32 v201, s21, v201
    v_cmp_u_f32 s[24:25], v128, v128
    s_nop 1
    s_cmp_lg_u64 s[24:25], 0
    s_cbranch_scc1 L_qa_redo_5
L_qa_ok_6:
    v_fmac_f32 v140, v174, v156
    v_fmac_f32 v141, v174, v157
    v_fmac_f32 v142, v174, v158
    v_fmac_f32 v143, v174, v159
    v_mul_f32 v140, v140, v177
    v_mul_f32 v141, v141, v177
    v_mul_f32 v142, v142, v177
    v_mul_f32 v143, v143, v177
    v_cvt_pk_bf16_f32 v190, v140, v141
    v_cvt_pk_bf16_f32 v191, v142, v143
    v_mov_b32 v204, v190
    v_mov_b32 v205, v191
    s_and_b32 s21, s32, 7
    s_cmp_lg_u32 s21, 7
    s_cbranch_scc1 L_qa_nc_13
    s_movk_i32 s23, 0x3f80
    s_cmp_eq_u32 s32, 7
    s_cselect_b32 s21, 0x3f803f80, s23
    s_cselect_b32 s22, s23, 0
    v_mov_b32 v204, s21
    v_mov_b32 v205, s22
L_qa_nc_13:
    s_mov_b32 exec_lo, 0
    s_cmp_ge_u32 s32, 8
    s_cbranch_scc1 L_qa_v_10
    ds_write_b64 v200, v[204:205]
    s_branch L_qa_bar_11
L_qa_v_10:
    ds_write_b16 v201, v204
    ds_write_b16_d16_hi v201, v204 offset:16
    ds_write_b16 v201, v205 offset:32
    ds_write_b16_d16_hi v201, v205 offset:48
L_qa_bar_11:
    s_mov_b64 exec, -1
    v_add_u32 v200, 155648, v1
    s_waitcnt lgkmcnt(0)
    s_barrier
    s_cmp_lg_u32 s3, 0
    s_cbranch_scc1 L_qa_q_12
    ds_read_b128 v[204:207], v200
    s_lshr_b32 s22, s32, 2
    s_lshl_b32 s24, s31, 7
    s_add_u32 s24, s24, s30
    s_add_u32 s24, s24, 983040
    s_lshl_b32 s21, s22, 2
    s_add_u32 s24, s24, s21
    s_lshl_b32 s20, s31, 11
    s_add_u32 s20, s20, s30
    s_lshl_b32 s21, s22, 10
    s_add_u32 s23, s20, s21
    s_add_u32 s23, s23, 720896
    s_lshl_b32 s21, s22, 8
    s_add_u32 s20, s20, s21
    s_add_u32 s20, s20, 851456
    s_cmp_lt_u32 s22, 2
    s_cselect_b32 s20, s23, s20
    s_cselect_b64 s[26:27], -1, 0
    v_lshrrev_b32 v201, 4, v0
    v_lshlrev_b32 v201, 9, v201
    v_and_b32 v202, 15, v0
    v_lshl_add_u32 v201, v202, 4, v201
    v_cndmask_b32 v201, v201, v1, s[26:27]
    v_mov_b32 v202, 0
    v_lshlrev_b32 v200, 13, v2
    s_waitcnt lgkmcnt(0)
    v_min_u32 v204, s54, v204
    v_min_u32 v205, s54, v205
    v_min_u32 v206, s54, v206
    v_min_u32 v207, s54, v207
    buffer_store_dwordx4 v[204:207], v201, s[8:11], s20 offen sc1
    v_dot2_f32_bf16 v202, v204, v204, v202
    v_dot2_f32_bf16 v202, v205, v205, v202
    v_dot2_f32_bf16 v202, v206, v206, v202
    v_dot2_f32_bf16 v202, v207, v207, v202
    s_nop 2
    v_mov_b32 v203, v202
    s_nop 1
    v_permlane32_swap_b32 v202, v203
    s_nop 1
    v_add_f32 v202, v202, v203
    s_nop 1
    v_max_f32_dpp v202, v202, v202 quad_perm:[1,0,3,2] row_mask:0xf bank_mask:0xf
    s_nop 1
    v_max_f32_dpp v202, v202, v202 quad_perm:[2,3,0,1] row_mask:0xf bank_mask:0xf
    s_nop 1
    v_max_f32_dpp v202, v202, v202 row_half_mirror row_mask:0xf bank_mask:0xf
    s_nop 1
    v_max_f32_dpp v202, v202, v202 row_mirror row_mask:0xf bank_mask:0xf
    s_nop 1
    v_readlane_b32 s22, v202, 0
    v_readlane_b32 s23, v202, 16
    s_max_u32 s22, s22, s23
    s_min_u32 s22, s22, 0x7fc00000
    s_and_b32 s22, s22, s26
    v_mov_b32 v201, s22
    s_mov_b64 exec, 0xffff
    buffer_store_dword v201, v200, s[8:11], s24 offen sc1
    s_mov_b64 exec, -1
L_qa_q_12:
    v_min_u32 v190, s54, v190
    v_min_u32 v191, s54, v191
    v_pk_fma_f32 v[128:129], v[174:175], v[144:145], v[128:129] op_sel_hi:[0,1,1]
    v_pk_fma_f32 v[130:131], v[174:175], v[146:147], v[130:131] op_sel_hi:[0,1,1]
    v_pk_fma_f32 v[132:133], v[174:175], v[148:149], v[132:133] op_sel_hi:[0,1,1]
    v_pk_fma_f32 v[134:135], v[174:175], v[150:151], v[134:135] op_sel_hi:[0,1,1]
    v_pk_fma_f32 v[136:137], v[174:175], v[152:153], v[136:137] op_sel_hi:[0,1,1]
    v_pk_fma_f32 v[138:139], v[174:175], v[154:155], v[138:139] op_sel_hi:[0,1,1]
    v_pk_mul_f32 v[128:129], v[176:177], v[128:129] op_sel_hi:[0,1]
    v_pk_mul_f32 v[130:131], v[176:177], v[130:131] op_sel_hi:[0,1]
    v_pk_mul_f32 v[132:133], v[176:177], v[132:133] op_sel_hi:[0,1]
    v_pk_mul_f32 v[134:135], v[176:177], v[134:135] op_sel_hi:[0,1]
    v_pk_mul_f32 v[136:137], v[176:177], v[136:137] op_sel_hi:[0,1]
    v_pk_mul_f32 v[138:139], v[176:177], v[138:139] op_sel_hi:[0,1]
    v_cvt_pk_bf16_f32 v184, v128, v129
    v_cvt_pk_bf16_f32 v185, v130, v131
    v_cvt_pk_bf16_f32 v186, v132, v133
    v_cvt_pk_bf16_f32 v187, v134, v135
    v_cvt_pk_bf16_f32 v188, v136, v137
    v_cvt_pk_bf16_f32 v189, v138, v139
    v_min_u32 v184, s54, v184
    v_min_u32 v185, s54, v185
    v_min_u32 v186, s54, v186
    v_min_u32 v187, s54, v187
    v_min_u32 v188, s54, v188
    v_min_u32 v189, s54, v189
    s_lshl_b32 s20, s31, 15
    s_lshr_b32 s21, s32, 2
    s_lshl_b32 s21, s21, 11
    s_add_u32 s20, s20, s21
    s_lshl_b32 s21, s3, 7
    s_add_u32 s20, s20, s21
    s_add_u32 s47, s20, 1114112
    s_add_u32 s20, s47, s30
    buffer_store_dwordx4 v[184:187], v236, s[8:11], s20 offen sc1
    v_cndmask_b32 v178, v190, 0, vcc
    v_cndmask_b32 v179, v191, 0, vcc
    v_mov_b32 v176, 0
    v_mov_b32 v177, 0
    v_dot2_f32_bf16 v176, v184, v184, v176
    v_dot2_f32_bf16 v177, v185, v185, v177
    v_dot2_f32_bf16 v176, v186, v186, v176
    v_dot2_f32_bf16 v177, v187, v187, v177
    v_dot2_f32_bf16 v176, v188, v188, v176
    v_dot2_f32_bf16 v177, v189, v189, v177
    v_dot2_f32_bf16 v176, v178, v178, v176
    v_dot2_f32_bf16 v177, v179, v179, v177
    v_mov_b32 v192, v188
    v_mov_b32 v193, v189
    v_mov_b32 v195, v179
    s_nop 0
    v_add_f32 v176, v176, v177
    v_mov_b32 v177, v176
    s_nop 1
    v_permlane32_swap_b32 v176, v177
    s_nop 1
    v_add_f32 v176, v176, v177
    v_min_u32 v176, s54, v176
    v_cndmask_b32 v194, v190, v176, vcc
    buffer_store_dwordx4 v[192:195], v236, s[8:11], s20 offen offset:1024 sc1
    s_barrier
    s_lshl_b32 s21, s6, 11
    s_add_u32 s21, s21, s30
    s_add_u32 s21, s21, 983040
    v_and_b32 v224, 15, v2
    v_lshlrev_b32 v224, 7, v224
    s_lshl_b32 s20, s7, 13
    s_add_u32 s20, s20, s30
    s_add_u32 s20, s20, 1114112
    s_lshl_b32 s26, s3, 11
    s_add_u32 s27, s26, 2048
    s_and_b32 s27, s27, 0x1fff
    s_add_u32 s28, s26, 4096
    s_and_b32 s28, s28, 0x1fff
    s_add_u32 s53, s26, 6144
    s_and_b32 s53, s53, 0x1fff
    s_lshr_b32 s57, s27, 2
    s_lshr_b32 s58, s28, 2
    s_lshr_b32 s59, s53, 2
    s_add_u32 s26, s26, s20
    s_add_u32 s27, s27, s20
    s_add_u32 s28, s28, s20
    s_add_u32 s53, s53, s20
    s_lshl_b32 s22, s3, 15
    s_add_u32 s22, s22, s30
    s_add_u32 s23, s22, 851968
    s_add_u32 s22, s22, 720896
    v_mov_b32 v88, 0
    v_mov_b32 v89, 0
    v_mov_b32 v90, 0
    v_mov_b32 v91, 0
    v_mov_b32 v92, 0
    v_mov_b32 v93, 0
    v_mov_b32 v94, 0
    v_mov_b32 v95, 0
    v_mov_b32 v96, 0
    v_mov_b32 v97, 0
    v_mov_b32 v98, 0
    v_mov_b32 v99, 0
    v_mov_b32 v100, 0
    v_mov_b32 v101, 0
    v_mov_b32 v102, 0
    v_mov_b32 v103, 0
    v_mov_b32 v104, 0
    v_mov_b32 v105, 0
    v_mov_b32 v106, 0
    v_mov_b32 v107, 0
    v_mov_b32 v108, 0
    v_mov_b32 v109, 0
    v_mov_b32 v110, 0
    v_mov_b32 v111, 0
    v_mov_b32 v112, 0
    v_mov_b32 v113, 0
    v_mov_b32 v114, 0
    v_mov_b32 v115, 0
    v_mov_b32 v116, 0
    v_mov_b32 v117, 0
    v_mov_b32 v118, 0
    v_mov_b32 v119, 0
    v_mov_b32 v120, 0
    v_mov_b32 v121, 0
    v_mov_b32 v122, 0
    v_mov_b32 v123, 0
    v_mov_b32 v124, 0
    v_mov_b32 v125, 0
    v_mov_b32 v126, 0
    v_mov_b32 v127, 0
    v_mov_b32 v128, 0
    v_mov_b32 v129, 0
    v_mov_b32 v130, 0
    v_mov_b32 v131, 0
    v_mov_b32 v132, 0
    v_mov_b32 v133, 0
    v_mov_b32 v134, 0
    v_mov_b32 v135, 0
    v_mov_b32 v136, 0
    v_mov_b32 v137, 0
    v_mov_b32 v138, 0
    v_mov_b32 v139, 0
    v_mov_b32 v140, 0
    v_mov_b32 v141, 0
    v_mov_b32 v142, 0
    v_mov_b32 v143, 0
    v_mov_b32 v144, 0
    v_mov_b32 v145, 0
    v_mov_b32 v146, 0
    v_mov_b32 v147, 0
    v_mov_b32 v148, 0
    v_mov_b32 v149, 0
    v_mov_b32 v150, 0
    v_mov_b32 v151, 0
    v_mov_b32 v80, 0
    v_mov_b32 v81, 0
    v_mov_b32 v82, 0
    v_mov_b32 v83, 0
    v_mov_b32 v84, 0
    v_mov_b32 v85, 0
    v_mov_b32 v86, 0
    v_mov_b32 v87, 0
    v_mov_b32 v212, 0
    v_mov_b32 v213, 0
    v_mov_b32 v214, 0
    v_mov_b32 v215, 0
    v_mov_b32 v232, -1
    v_mov_b32 v233, -1
    v_mov_b32 v234, -1
    v_mov_b32 v235, -1
    s_lshl_b32 s55, s36, 15
    s_add_u32 s55, s55, 458752
    buffer_load_dwordx4 v[16:19], v1, s[8:11], s26 offen
    buffer_load_dwordx4 v[20:23], v1, s[8:11], s26 offen offset:1024
    buffer_load_dwordx4 v[24:27], v1, s[8:11], s27 offen
    buffer_load_dwordx4 v[28:31], v1, s[8:11], s27 offen offset:1024
    buffer_load_dwordx4 v[32:35], v1, s[8:11], s28 offen
    buffer_load_dwordx4 v[36:39], v1, s[8:11], s28 offen offset:1024
    buffer_load_dwordx4 v[40:43], v1, s[8:11], s53 offen
    buffer_load_dwordx4 v[44:47], v1, s[8:11], s53 offen offset:1024
    s_lshl_b32 s41, s5, 17
    s_lshl_b32 s42, s6, 11
    s_add_u32 s41, s41, s42
    s_add_u32 s41, s41, s30
    s_add_u32 s42, s41, 11075584
    s_add_u32 s41, s41, 8978432
    s_lshl_b32 s43, s6, 15
    s_lshl_b32 s44, s5, 11
    s_add_u32 s43, s43, s44
    s_add_u32 s43, s43, s30
    s_add_u32 s43, s43, 13172736
    s_mul_i32 s44, s31, 28672
    s_lshl_b32 s45, s36, 11
    s_add_u32 s44, s44, s45
    s_add_u32 s44, s44, s30
    s_add_u32 s52, s44, 18481152
    s_add_u32 s44, s44, 7143424
    s_lshr_b32 s45, s7, 2
    s_lshl_b32 s45, s45, 15
    s_and_b32 s46, s7, 3
    s_lshl_b32 s46, s46, 7
    s_add_u32 s45, s45, s46
    s_add_u32 s45, s45, s30
    s_add_u32 s45, s45, 5046272
    s_lshl_b32 s46, s3, 13
    s_add_u32 s45, s45, s46
    s_mov_b32 s56, s45
    s_add_u32 s46, s47, s30
    s_add_u32 s46, s46, 15269888
    v_mov_b32 v238, v237
    v_mov_b32 v239, v236
    s_mov_b32 s37, s22
    s_mov_b32 s38, s23
    s_lshl_b32 s20, s3, 9
    s_add_u32 s20, s20, 152576
    v_lshl_add_u32 v225, v2, 2, s20
    v_lshlrev_b32 v226, 2, v2
    v_add_u32 v226, 152576, v226
    v_add_u32 v227, s58, v226
    v_add_u32 v228, s59, v226
    v_add_u32 v226, s57, v226
    s_mov_b32 s35, 0
L_kn_14:
    buffer_load_dwordx4 v[216:219], v224, s[8:11], s21 offen sc1
    s_waitcnt vmcnt(0)
    v_max3_u32 v220, v216, v217, v218
    v_max_u32 v220, v220, v219
    v_cmp_eq_u32 vcc, -1, v220
    s_nop 1
    s_cmp_lg_u64 vcc, 0
    s_cbranch_scc1 L_kn_r_15
L_kn_ok_16:
    buffer_load_dwordx4 v[152:155], v1, s[8:11], s22 offen
    buffer_load_dwordx4 v[156:159], v1, s[8:11], s22 offen offset:1024
    buffer_load_dwordx4 v[160:163], v1, s[8:11], s23 offen
    buffer_load_dwordx4 v[164:167], v1, s[8:11], s23 offen offset:1024
    s_add_u32 s22, s22, 2048
    s_add_u32 s23, s23, 2048
    buffer_load_dwordx4 v[168:171], v1, s[8:11], s22 offen
    buffer_load_dwordx4 v[172:175], v1, s[8:11], s22 offen offset:1024
    buffer_load_dwordx4 v[176:179], v1, s[8:11], s23 offen
    buffer_load_dwordx4 v[180:183], v1, s[8:11], s23 offen offset:1024
    s_add_u32 s22, s22, 2048
    s_add_u32 s23, s23, 2048
    buffer_load_dwordx4 v[184:187], v1, s[8:11], s22 offen
    buffer_load_dwordx4 v[188:191], v1, s[8:11], s22 offen offset:1024
    buffer_load_dwordx4 v[192:195], v1, s[8:11], s23 offen
    buffer_load_dwordx4 v[196:199], v1, s[8:11], s23 offen offset:1024
    s_add_u32 s22, s22, 2048
    s_add_u32 s23, s23, 2048
    v_add_f32 v216, v216, v217
    v_add_f32 v218, v218, v219
    v_add_f32 v216, v216, v218
    s_nop 1
    v_max_f32_dpp v216, v216, v216 quad_perm:[1,0,3,2] row_mask:0xf bank_mask:0xf
    s_nop 1
    v_max_f32_dpp v216, v216, v216 quad_perm:[2,3,0,1] row_mask:0xf bank_mask:0xf
    s_nop 1
    v_max_f32_dpp v216, v216, v216 row_half_mirror row_mask:0xf bank_mask:0xf
    s_nop 1
    v_max_f32_dpp v216, v216, v216 row_mirror row_mask:0xf bank_mask:0xf
    s_nop 1
    v_readfirstlane_b32 s24, v216
    v_max3_u32 v216, v16, v17, v18
    v_max3_u32 v216, v216, v19, v20
    v_max3_u32 v216, v216, v21, v22
    v_max3_u32 v216, v216, v23, v24
    v_max3_u32 v216, v216, v25, v26
    v_max3_u32 v216, v216, v27, v28
    v_max3_u32 v216, v216, v29, v30
    v_max3_u32 v216, v216, v31, v32
    v_max3_u32 v216, v216, v33, v34
    v_max3_u32 v216, v216, v35, v36
    v_max3_u32 v216, v216, v37, v38
    v_max3_u32 v216, v216, v39, v40
    v_max3_u32 v216, v216, v41, v42
    v_max3_u32 v216, v216, v43, v44
    v_max3_u32 v216, v216, v45, v46
    v_max_u32 v216, v216, v47
    v_cmp_eq_u32 vcc, -1, v216
    s_nop 1
    s_cmp_lg_u64 vcc, 0
    s_cbranch_scc1 L_qa_r_17
L_qa_ok_18:
    s_mov_b32 exec_lo, 0
    v_mul_f32 v216, s24, v22
    v_sqrt_f32 v216, v216
    s_nop 0
    v_mul_f32 v216, 0x3f828f5c, v216
    ds_write_b32 v225, v216 offset:0
    v_and_b32 v217, 0xffff0000, v216
    v_sub_f32 v218, v216, v217
    v_and_b32 v219, 0xffff0000, v218
    v_sub_f32 v218, v218, v219
    v_lshrrev_b32 v217, 16, v217
    v_or_b32 v217, v217, v219
    v_lshrrev_b32 v218, 16, v218
    v_xor_b32 v22, 0x80008000, v217
    v_xor_b32 v23, 0x00008000, v218
    v_mul_f32 v216, s24, v30
    v_sqrt_f32 v216, v216
    s_nop 0
    v_mul_f32 v216, 0x3f828f5c, v216
    ds_write_b32 v226, v216 offset:128
    v_and_b32 v217, 0xffff0000, v216
    v_sub_f32 v218, v216, v217
    v_and_b32 v219, 0xffff0000, v218
    v_sub_f32 v218, v218, v219
    v_lshrrev_b32 v217, 16, v217
    v_or_b32 v217, v217, v219
    v_lshrrev_b32 v218, 16, v218
    v_xor_b32 v30, 0x80008000, v217
    v_xor_b32 v31, 0x00008000, v218
    v_mul_f32 v216, s24, v38
    v_sqrt_f32 v216, v216
    s_nop 0
    v_mul_f32 v216, 0x3f828f5c, v216
    ds_write_b32 v227, v216 offset:256
    v_and_b32 v217, 0xffff0000, v216
    v_sub_f32 v218, v216, v217
    v_and_b32 v219, 0xffff0000, v218
    v_sub_f32 v218, v218, v219
    v_lshrrev_b32 v217, 16, v217
    v_or_b32 v217, v217, v219
    v_lshrrev_b32 v218, 16, v218
    v_xor_b32 v38, 0x80008000, v217
    v_xor_b32 v39, 0x00008000, v218
    v_mul_f32 v216, s24, v46
    v_sqrt_f32 v216, v216
    s_nop 0
    v_mul_f32 v216, 0x3f828f5c, v216
    ds_write_b32 v228, v216 offset:384
    v_and_b32 v217, 0xffff0000, v216
    v_sub_f32 v218, v216, v217
    v_and_b32 v219, 0xffff0000, v218
    v_sub_f32 v218, v218, v219
    v_lshrrev_b32 v217, 16, v217
    v_or_b32 v217, v217, v219
    v_lshrrev_b32 v218, 16, v218
    v_xor_b32 v46, 0x80008000, v217
    v_xor_b32 v47, 0x00008000, v218
    s_mov_b64 exec, -1
    s_waitcnt vmcnt(0)
    v_max3_u32 v216, v152, v153, v154
    v_max3_u32 v216, v216, v155, v156
    v_max3_u32 v216, v216, v157, v158
    v_max3_u32 v216, v216, v159, v160
    v_max3_u32 v216, v216, v161, v162
    v_max3_u32 v216, v216, v163, v164
    v_max3_u32 v216, v216, v165, v166
    v_max3_u32 v216, v216, v167, v168
    v_max3_u32 v216, v216, v169, v170
    v_max3_u32 v216, v216, v171, v172
    v_max3_u32 v216, v216, v173, v174
    v_max3_u32 v216, v216, v175, v176
    v_max3_u32 v216, v216, v177, v178
    v_max3_u32 v216, v216, v179, v180
    v_max3_u32 v216, v216, v181, v182
    v_max3_u32 v216, v216, v183, v184
    v_max3_u32 v216, v216, v185, v186
    v_max3_u32 v216, v216, v187, v188
    v_max3_u32 v216, v216, v189, v190
    v_max3_u32 v216, v216, v191, v192
    v_max3_u32 v216, v216, v193, v194
    v_max3_u32 v216, v216, v195, v196
    v_max3_u32 v216, v216, v197, v198
    v_max_u32 v216, v216, v199
    v_cmp_eq_u32 vcc, -1, v216
    s_nop 1
    s_cmp_lg_u64 vcc, 0
    s_cbranch_scc1 L_kv_r_20
L_kv_ok_21:
    v_mfma_f32_32x32x16_bf16 v[48:63], v[152:155], v[16:19], 0
    v_mfma_f32_32x32x16_bf16 v[48:63], v[156:159], v[20:23], v[48:63]
    s_mov_b32 s29, 0
    s_add_u32 s22, s22, 4096
    s_add_u32 s23, s23, 4096
    s_add_u32 s60, s16, s22
    s_addc_u32 s61, s17, 0
    s_add_u32 s62, s16, s23
    s_addc_u32 s63, s17, 0
    s_add_u32 s55, s55, 4096
    s_add_u32 s48, s16, s55
    s_addc_u32 s49, s17, 0
    s_nop 2
    v_exp_f32 v48, v48
    v_exp_f32 v49, v49
    v_exp_f32 v50, v50
    v_exp_f32 v51, v51
    v_mfma_f32_32x32x16_bf16 v[64:79], v[152:155], v[24:27], 0
    v_cvt_pk_bf16_f32 v80, v48, v49
    v_cvt_pk_bf16_f32 v81, v50, v51
    global_load_dwordx4 a[112:115], v1, s[48:49] offset:-4096
    v_exp_f32 v52, v52
    v_exp_f32 v53, v53
    v_exp_f32 v54, v54
    v_exp_f32 v55, v55
    v_mfma_f32_32x32x16_bf16 v[64:79], v[156:159], v[28:31], v[64:79]
    v_cvt_pk_bf16_f32 v82, v52, v53
    v_cvt_pk_bf16_f32 v83, v54, v55
    v_exp_f32 v56, v56
    v_exp_f32 v57, v57
    v_exp_f32 v58, v58
    v_exp_f32 v59, v59
    v_mfma_f32_32x32x16_bf16 v[136:151], v[212:215], v[84:87], v[136:151]
    v_cvt_pk_bf16_f32 v84, v56, v57
    v_cvt_pk_bf16_f32 v85, v58, v59
    global_load_dwordx4 v[200:203], v1, s[60:61] offset:-4096
    global_load_dwordx4 v[204:207], v1, s[60:61] offset:-3072
    global_load_dwordx4 v[208:211], v1, s[62:63] offset:-4096
    global_load_dwordx4 v[212:215], v1, s[62:63] offset:-3072
    v_exp_f32 v60, v60
    v_exp_f32 v61, v61
    v_exp_f32 v62, v62
    v_exp_f32 v63, v63
    v_mfma_f32_32x32x16_bf16 v[88:103], v[160:163], v[80:83], v[88:103]
    v_cvt_pk_bf16_f32 v86, v60, v61
    v_cvt_pk_bf16_f32 v87, v62, v63
    global_load_dwordx4 a[116:119], v1, s[48:49] offset:-3072
    v_exp_f32 v64, v64
    v_exp_f32 v65, v65
    v_exp_f32 v66, v66
    v_exp_f32 v67, v67
    v_mfma_f32_32x32x16_bf16 v[48:63], v[152:155], v[32:35], 0
    v_cvt_pk_bf16_f32 v80, v64, v65
    v_cvt_pk_bf16_f32 v81, v66, v67
    global_load_dwordx4 a[120:123], v1, s[48:49] offset:-2048
    v_exp_f32 v68, v68
    v_exp_f32 v69, v69
    v_exp_f32 v70, v70
    v_exp_f32 v71, v71
    v_mfma_f32_32x32x16_bf16 v[48:63], v[156:159], v[36:39], v[48:63]
    v_cvt_pk_bf16_f32 v82, v68, v69
    v_cvt_pk_bf16_f32 v83, v70, v71
    v_exp_f32 v72, v72
    v_exp_f32 v73, v73
    v_exp_f32 v74, v74
    v_exp_f32 v75, v75
    v_mfma_f32_32x32x16_bf16 v[88:103], v[164:167], v[84:87], v[88:103]
    v_cvt_pk_bf16_f32 v84, v72, v73
    v_cvt_pk_bf16_f32 v85, v74, v75
    v_exp_f32 v76, v76
    v_exp_f32 v77, v77
    v_exp_f32 v78, v78
    v_exp_f32 v79, v79
    v_mfma_f32_32x32x16_bf16 v[104:119], v[160:163], v[80:83], v[104:119]
    v_cvt_pk_bf16_f32 v86, v76, v77
    v_cvt_pk_bf16_f32 v87, v78, v79
    global_load_dwordx4 a[124:127], v1, s[48:49] offset:-1024
    v_exp_f32 v48, v48
    v_exp_f32 v49, v49
    v_exp_f32 v50, v50
    v_exp_f32 v51, v51
    v_mfma_f32_32x32x16_bf16 v[64:79], v[152:155], v[40:43], 0
    v_cvt_pk_bf16_f32 v80, v48, v49
    v_cvt_pk_bf16_f32 v81, v50, v51
    global_load_dwordx4 a[128:131], v1, s[48:49] offset:0
    v_exp_f32 v52, v52
    v_exp_f32 v53, v53
    v_exp_f32 v54, v54
    v_exp_f32 v55, v55
    v_mfma_f32_32x32x16_bf16 v[64:79], v[156:159], v[44:47], v[64:79]
    v_cvt_pk_bf16_f32 v82, v52, v53
    v_cvt_pk_bf16_f32 v83, v54, v55
    v_exp_f32 v56, v56
    v_exp_f32 v57, v57
    v_exp_f32 v58, v58
    v_exp_f32 v59, v59
    v_mfma_f32_32x32x16_bf16 v[104:119], v[164:167], v[84:87], v[104:119]
    v_cvt_pk_bf16_f32 v84, v56, v57
    v_cvt_pk_bf16_f32 v85, v58, v59
    buffer_store_dwordx4 v[232:235], v1, s[8:11], s41 offen offset:0 sc1
    v_exp_f32 v60, v60
    v_exp_f32 v61, v61
    v_exp_f32 v62, v62
    v_exp_f32 v63, v63
    v_mfma_f32_32x32x16_bf16 v[120:135], v[160:163], v[80:83], v[120:135]
    v_cvt_pk_bf16_f32 v86, v60, v61
    v_cvt_pk_bf16_f32 v87, v62, v63
    global_load_dwordx4 a[132:135], v1, s[48:49] offset:1024
    v_exp_f32 v64, v64
    v_exp_f32 v65, v65
    v_exp_f32 v66, v66
    v_exp_f32 v67, v67
    v_mfma_f32_32x32x16_bf16 v[48:63], v[168:171], v[16:19], 0
    v_cvt_pk_bf16_f32 v80, v64, v65
    v_cvt_pk_bf16_f32 v81, v66, v67
    global_load_dwordx4 a[136:139], v1, s[48:49] offset:2048
    v_exp_f32 v68, v68
    v_exp_f32 v69, v69
    v_exp_f32 v70, v70
    v_exp_f32 v71, v71
    v_mfma_f32_32x32x16_bf16 v[48:63], v[172:175], v[20:23], v[48:63]
    v_cvt_pk_bf16_f32 v82, v68, v69
    v_cvt_pk_bf16_f32 v83, v70, v71
    v_exp_f32 v72, v72
    v_exp_f32 v73, v73
    v_exp_f32 v74, v74
    v_exp_f32 v75, v75
    v_mfma_f32_32x32x16_bf16 v[120:135], v[164:167], v[84:87], v[120:135]
    v_cvt_pk_bf16_f32 v84, v72, v73
    v_cvt_pk_bf16_f32 v85, v74, v75
    v_exp_f32 v76, v76
    v_exp_f32 v77, v77
    v_exp_f32 v78, v78
    v_exp_f32 v79, v79
    v_mfma_f32_32x32x16_bf16 v[136:151], v[160:163], v[80:83], v[136:151]
    v_cvt_pk_bf16_f32 v86, v76, v77
    v_cvt_pk_bf16_f32 v87, v78, v79
    global_load_dwordx4 a[140:143], v1, s[48:49] offset:3072
    v_exp_f32 v48, v48
    v_exp_f32 v49, v49
    v_exp_f32 v50, v50
    v_exp_f32 v51, v51
    v_mfma_f32_32x32x16_bf16 v[64:79], v[168:171], v[24:27], 0
    v_cvt_pk_bf16_f32 v80, v48, v49
    v_cvt_pk_bf16_f32 v81, v50, v51
    s_add_u32 s48, s48, 8192
    s_addc_u32 s49, s49, 0
    global_load_dwordx4 a[144:147], v1, s[48:49] offset:-4096
    v_exp_f32 v52, v52
    v_exp_f32 v53, v53
    v_exp_f32 v54, v54
    v_exp_f32 v55, v55
    v_mfma_f32_32x32x16_bf16 v[64:79], v[172:175], v[28:31], v[64:79]
    v_cvt_pk_bf16_f32 v82, v52, v53
    v_cvt_pk_bf16_f32 v83, v54, v55
    v_exp_f32 v56, v56
    v_exp_f32 v57, v57
    v_exp_f32 v58, v58
    v_exp_f32 v59, v59
    v_mfma_f32_32x32x16_bf16 v[136:151], v[164:167], v[84:87], v[136:151]
    v_cvt_pk_bf16_f32 v84, v56, v57
    v_cvt_pk_bf16_f32 v85, v58, v59
    global_load_dwordx4 v[152:155], v1, s[60:61] offset:-2048
    global_load_dwordx4 v[156:159], v1, s[60:61] offset:-1024
    global_load_dwordx4 v[160:163], v1, s[62:63] offset:-2048
    global_load_dwordx4 v[164:167], v1, s[62:63] offset:-1024
    v_exp_f32 v60, v60
    v_exp_f32 v61, v61
    v_exp_f32 v62, v62
    v_exp_f32 v63, v63
    v_mfma_f32_32x32x16_bf16 v[88:103], v[176:179], v[80:83], v[88:103]
    v_cvt_pk_bf16_f32 v86, v60, v61
    v_cvt_pk_bf16_f32 v87, v62, v63
    global_load_dwordx4 a[148:151], v1, s[48:49] offset:-3072
    v_exp_f32 v64, v64
    v_exp_f32 v65, v65
    v_exp_f32 v66, v66
    v_exp_f32 v67, v67
    v_mfma_f32_32x32x16_bf16 v[48:63], v[168:171], v[32:35], 0
    v_cvt_pk_bf16_f32 v80, v64, v65
    v_cvt_pk_bf16_f32 v81, v66, v67
    global_load_dwordx4 a[152:155], v1, s[48:49] offset:-2048
    v_exp_f32 v68, v68
    v_exp_f32 v69, v69
    v_exp_f32 v70, v70
    v_exp_f32 v71, v71
    v_mfma_f32_32x32x16_bf16 v[48:63], v[172:175], v[36:39], v[48:63]
    v_cvt_pk_bf16_f32 v82, v68, v69
    v_cvt_pk_bf16_f32 v83, v70, v71
    v_exp_f32 v72, v72
    v_exp_f32 v73, v73
    v_exp_f32 v74, v74
    v_exp_f32 v75, v75
    v_mfma_f32_32x32x16_bf16 v[88:103], v[180:183], v[84:87], v[88:103]
    v_cvt_pk_bf16_f32 v84, v72, v73
    v_cvt_pk_bf16_f32 v85, v74, v75
    v_exp_f32 v76, v76
    v_exp_f32 v77, v77
    v_exp_f32 v78, v78
    v_exp_f32 v79, v79
    v_mfma_f32_32x32x16_bf16 v[104:119], v[176:179], v[80:83], v[104:119]
    v_cvt_pk_bf16_f32 v86, v76, v77
    v_cvt_pk_bf16_f32 v87, v78, v79
    global_load_dwordx4 a[156:159], v1, s[48:49] offset:-1024
    v_exp_f32 v48, v48
    v_exp_f32 v49, v49
    v_exp_f32 v50, v50
    v_exp_f32 v51, v51
    v_mfma_f32_32x32x16_bf16 v[64:79], v[168:171], v[40:43], 0
    v_cvt_pk_bf16_f32 v80, v48, v49
    v_cvt_pk_bf16_f32 v81, v50, v51
    global_load_dwordx4 a[160:163], v1, s[48:49] offset:0
    v_exp_f32 v52, v52
    v_exp_f32 v53, v53
    v_exp_f32 v54, v54
    v_exp_f32 v55, v55
    v_mfma_f32_32x32x16_bf16 v[64:79], v[172:175], v[44:47], v[64:79]
    v_cvt_pk_bf16_f32 v82, v52, v53
    v_cvt_pk_bf16_f32 v83, v54, v55
    v_exp_f32 v56, v56
    v_exp_f32 v57, v57
    v_exp_f32 v58, v58
    v_exp_f32 v59, v59
    v_mfma_f32_32x32x16_bf16 v[104:119], v[180:183], v[84:87], v[104:119]
    v_cvt_pk_bf16_f32 v84, v56, v57
    v_cvt_pk_bf16_f32 v85, v58, v59
    buffer_store_dwordx4 v[232:235], v1, s[8:11], s41 offen offset:1024 sc1
    v_exp_f32 v60, v60
    v_exp_f32 v61, v61
    v_exp_f32 v62, v62
    v_exp_f32 v63, v63
    v_mfma_f32_32x32x16_bf16 v[120:135], v[176:179], v[80:83], v[120:135]
    v_cvt_pk_bf16_f32 v86, v60, v61
    v_cvt_pk_bf16_f32 v87, v62, v63
    global_load_dwordx4 a[164:167], v1, s[48:49] offset:1024
    v_exp_f32 v64, v64
    v_exp_f32 v65, v65
    v_exp_f32 v66, v66
    v_exp_f32 v67, v67
    v_mfma_f32_32x32x16_bf16 v[48:63], v[184:187], v[16:19], 0
    v_cvt_pk_bf16_f32 v80, v64, v65
    v_cvt_pk_bf16_f32 v81, v66, v67
    global_load_dwordx4 a[168:171], v1, s[48:49] offset:2048
    v_exp_f32 v68, v68
    v_exp_f32 v69, v69
    v_exp_f32 v70, v70
    v_exp_f32 v71, v71
    v_mfma_f32_32x32x16_bf16 v[48:63], v[188:191], v[20:23], v[48:63]
    v_cvt_pk_bf16_f32 v82, v68, v69
    v_cvt_pk_bf16_f32 v83, v70, v71
    v_exp_f32 v72, v72
    v_exp_f32 v73, v73
    v_exp_f32 v74, v74
    v_exp_f32 v75, v75
    v_mfma_f32_32x32x16_bf16 v[120:135], v[180:183], v[84:87], v[120:135]
    v_cvt_pk_bf16_f32 v84, v72, v73
    v_cvt_pk_bf16_f32 v85, v74, v75
    v_exp_f32 v76, v76
    v_exp_f32 v77, v77
    v_exp_f32 v78, v78
    v_exp_f32 v79, v79
    v_mfma_f32_32x32x16_bf16 v[136:151], v[176:179], v[80:83], v[136:151]
    v_cvt_pk_bf16_f32 v86, v76, v77
    v_cvt_pk_bf16_f32 v87, v78, v79
    global_load_dwordx4 a[172:175], v1, s[48:49] offset:3072
    v_exp_f32 v48, v48
    v_exp_f32 v49, v49
    v_exp_f32 v50, v50
    v_exp_f32 v51, v51
    v_mfma_f32_32x32x16_bf16 v[64:79], v[184:187], v[24:27], 0
    v_cvt_pk_bf16_f32 v80, v48, v49
    v_cvt_pk_bf16_f32 v81, v50, v51
    s_add_u32 s48, s48, 8192
    s_addc_u32 s49, s49, 0
    global_load_dwordx4 a[176:179], v1, s[48:49] offset:-4096
    v_exp_f32 v52, v52
    v_exp_f32 v53, v53
    v_exp_f32 v54, v54
    v_exp_f32 v55, v55
    v_mfma_f32_32x32x16_bf16 v[64:79], v[188:191], v[28:31], v[64:79]
    v_cvt_pk_bf16_f32 v82, v52, v53
    v_cvt_pk_bf16_f32 v83, v54, v55
    v_exp_f32 v56, v56
    v_exp_f32 v57, v57
    v_exp_f32 v58, v58
    v_exp_f32 v59, v59
    v_mfma_f32_32x32x16_bf16 v[136:151], v[180:183], v[84:87], v[136:151]
    v_cvt_pk_bf16_f32 v84, v56, v57
    v_cvt_pk_bf16_f32 v85, v58, v59
    global_load_dwordx4 v[168:171], v1, s[60:61] offset:0
    global_load_dwordx4 v[172:175], v1, s[60:61] offset:1024
    global_load_dwordx4 v[176:179], v1, s[62:63] offset:0
    global_load_dwordx4 v[180:183], v1, s[62:63] offset:1024
    v_exp_f32 v60, v60
    v_exp_f32 v61, v61
    v_exp_f32 v62, v62
    v_exp_f32 v63, v63
    v_mfma_f32_32x32x16_bf16 v[88:103], v[192:195], v[80:83], v[88:103]
    v_cvt_pk_bf16_f32 v86, v60, v61
    v_cvt_pk_bf16_f32 v87, v62, v63
    global_load_dwordx4 a[180:183], v1, s[48:49] offset:-3072
    v_exp_f32 v64, v64
    v_exp_f32 v65, v65
    v_exp_f32 v66, v66
    v_exp_f32 v67, v67
    v_mfma_f32_32x32x16_bf16 v[48:63], v[184:187], v[32:35], 0
    v_cvt_pk_bf16_f32 v80, v64, v65
    v_cvt_pk_bf16_f32 v81, v66, v67
    global_load_dwordx4 a[184:187], v1, s[48:49] offset:-2048
    v_exp_f32 v68, v68
    v_exp_f32 v69, v69
    v_exp_f32 v70, v70
    v_exp_f32 v71, v71
    v_mfma_f32_32x32x16_bf16 v[48:63], v[188:191], v[36:39], v[48:63]
    v_cvt_pk_bf16_f32 v82, v68, v69
    v_cvt_pk_bf16_f32 v83, v70, v71
    v_exp_f32 v72, v72
    v_exp_f32 v73, v73
    v_exp_f32 v74, v74
    v_exp_f32 v75, v75
    v_mfma_f32_32x32x16_bf16 v[88:103], v[196:199], v[84:87], v[88:103]
    v_cvt_pk_bf16_f32 v84, v72, v73
    v_cvt_pk_bf16_f32 v85, v74, v75
    v_exp_f32 v76, v76
    v_exp_f32 v77, v77
    v_exp_f32 v78, v78
    v_exp_f32 v79, v79
    v_mfma_f32_32x32x16_bf16 v[104:119], v[192:195], v[80:83], v[104:119]
    v_cvt_pk_bf16_f32 v86, v76, v77
    v_cvt_pk_bf16_f32 v87, v78, v79
    global_load_dwordx4 a[188:191], v1, s[48:49] offset:-1024
    v_exp_f32 v48, v48
    v_exp_f32 v49, v49
    v_exp_f32 v50, v50
    v_exp_f32 v51, v51
    v_mfma_f32_32x32x16_bf16 v[64:79], v[184:187], v[40:43], 0
    v_cvt_pk_bf16_f32 v80, v48, v49
    v_cvt_pk_bf16_f32 v81, v50, v51
    global_load_dwordx4 a[192:195], v1, s[48:49] offset:0
    v_exp_f32 v52, v52
    v_exp_f32 v53, v53
    v_exp_f32 v54, v54
    v_exp_f32 v55, v55
    v_mfma_f32_32x32x16_bf16 v[64:79], v[188:191], v[44:47], v[64:79]
    v_cvt_pk_bf16_f32 v82, v52, v53
    v_cvt_pk_bf16_f32 v83, v54, v55
    v_exp_f32 v56, v56
    v_exp_f32 v57, v57
    v_exp_f32 v58, v58
    v_exp_f32 v59, v59
    v_mfma_f32_32x32x16_bf16 v[104:119], v[196:199], v[84:87], v[104:119]
    v_cvt_pk_bf16_f32 v84, v56, v57
    v_cvt_pk_bf16_f32 v85, v58, v59
    buffer_store_dwordx4 v[232:235], v238, s[8:11], s45 offen offset:0 sc1
    v_exp_f32 v60, v60
    v_exp_f32 v61, v61
    v_exp_f32 v62, v62
    v_exp_f32 v63, v63
    v_mfma_f32_32x32x16_bf16 v[120:135], v[192:195], v[80:83], v[120:135]
    v_cvt_pk_bf16_f32 v86, v60, v61
    v_cvt_pk_bf16_f32 v87, v62, v63
    global_load_dwordx4 a[196:199], v1, s[48:49] offset:1024
    v_exp_f32 v64, v64
    v_exp_f32 v65, v65
    v_exp_f32 v66, v66
    v_exp_f32 v67, v67
    s_waitcnt vmcnt(32)
    v_mfma_f32_32x32x16_bf16 v[48:63], v[200:203], v[16:19], 0
    v_cvt_pk_bf16_f32 v80, v64, v65
    v_cvt_pk_bf16_f32 v81, v66, v67
    global_load_dwordx4 a[200:203], v1, s[48:49] offset:2048
    v_exp_f32 v68, v68
    v_exp_f32 v69, v69
    v_exp_f32 v70, v70
    v_exp_f32 v71, v71
    v_mfma_f32_32x32x16_bf16 v[48:63], v[204:207], v[20:23], v[48:63]
    v_cvt_pk_bf16_f32 v82, v68, v69
    v_cvt_pk_bf16_f32 v83, v70, v71
    v_exp_f32 v72, v72
    v_exp_f32 v73, v73
    v_exp_f32 v74, v74
    v_exp_f32 v75, v75
    v_mfma_f32_32x32x16_bf16 v[120:135], v[196:199], v[84:87], v[120:135]
    v_cvt_pk_bf16_f32 v84, v72, v73
    v_cvt_pk_bf16_f32 v85, v74, v75
    v_exp_f32 v76, v76
    v_exp_f32 v77, v77
    v_exp_f32 v78, v78
    v_exp_f32 v79, v79
    v_mfma_f32_32x32x16_bf16 v[136:151], v[192:195], v[80:83], v[136:151]
    v_cvt_pk_bf16_f32 v86, v76, v77
    v_cvt_pk_bf16_f32 v87, v78, v79
    global_load_dwordx4 a[204:207], v1, s[48:49] offset:3072
    v_exp_f32 v48, v48
    v_exp_f32 v49, v49
    v_exp_f32 v50, v50
    v_exp_f32 v51, v51
    v_mfma_f32_32x32x16_bf16 v[64:79], v[200:203], v[24:27], 0
    v_cvt_pk_bf16_f32 v80, v48, v49
    v_cvt_pk_bf16_f32 v81, v50, v51
    s_add_u32 s48, s48, 8192
    s_addc_u32 s49, s49, 0
    global_load_dwordx4 a[208:211], v1, s[48:49] offset:-4096
    v_exp_f32 v52, v52
    v_exp_f32 v53, v53
    v_exp_f32 v54, v54
    v_exp_f32 v55, v55
    v_mfma_f32_32x32x16_bf16 v[64:79], v[204:207], v[28:31], v[64:79]
    v_cvt_pk_bf16_f32 v82, v52, v53
    v_cvt_pk_bf16_f32 v83, v54, v55
    v_exp_f32 v56, v56
    v_exp_f32 v57, v57
    v_exp_f32 v58, v58
    v_exp_f32 v59, v59
    v_mfma_f32_32x32x16_bf16 v[136:151], v[196:199], v[84:87], v[136:151]
    v_cvt_pk_bf16_f32 v84, v56, v57
    v_cvt_pk_bf16_f32 v85, v58, v59
    global_load_dwordx4 v[184:187], v1, s[60:61] offset:2048
    global_load_dwordx4 v[188:191], v1, s[60:61] offset:3072
    global_load_dwordx4 v[192:195], v1, s[62:63] offset:2048
    global_load_dwordx4 v[196:199], v1, s[62:63] offset:3072
    v_exp_f32 v60, v60
    v_exp_f32 v61, v61
    v_exp_f32 v62, v62
    v_exp_f32 v63, v63
    v_mfma_f32_32x32x16_bf16 v[88:103], v[208:211], v[80:83], v[88:103]
    v_cvt_pk_bf16_f32 v86, v60, v61
    v_cvt_pk_bf16_f32 v87, v62, v63
    global_load_dwordx4 a[212:215], v1, s[48:49] offset:-3072
    v_exp_f32 v64, v64
    v_exp_f32 v65, v65
    v_exp_f32 v66, v66
    v_exp_f32 v67, v67
    v_mfma_f32_32x32x16_bf16 v[48:63], v[200:203], v[32:35], 0
    v_cvt_pk_bf16_f32 v80, v64, v65
    v_cvt_pk_bf16_f32 v81, v66, v67
    global_load_dwordx4 a[216:219], v1, s[48:49] offset:-2048
    v_exp_f32 v68, v68
    v_exp_f32 v69, v69
    v_exp_f32 v70, v70
    v_exp_f32 v71, v71
    v_mfma_f32_32x32x16_bf16 v[48:63], v[204:207], v[36:39], v[48:63]
    v_cvt_pk_bf16_f32 v82, v68, v69
    v_cvt_pk_bf16_f32 v83, v70, v71
    v_exp_f32 v72, v72
    v_exp_f32 v73, v73
    v_exp_f32 v74, v74
    v_exp_f32 v75, v75
    v_mfma_f32_32x32x16_bf16 v[88:103], v[212:215], v[84:87], v[88:103]
    v_cvt_pk_bf16_f32 v84, v72, v73
    v_cvt_pk_bf16_f32 v85, v74, v75
    v_exp_f32 v76, v76
    v_exp_f32 v77, v77
    v_exp_f32 v78, v78
    v_exp_f32 v79, v79
    v_mfma_f32_32x32x16_bf16 v[104:119], v[208:211], v[80:83], v[104:119]
    v_cvt_pk_bf16_f32 v86, v76, v77
    v_cvt_pk_bf16_f32 v87, v78, v79
    global_load_dwordx4 a[220:223], v1, s[48:49] offset:-1024
    v_exp_f32 v48, v48
    v_exp_f32 v49, v49
    v_exp_f32 v50, v50
    v_exp_f32 v51, v51
    v_mfma_f32_32x32x16_bf16 v[64:79], v[200:203], v[40:43], 0
    v_cvt_pk_bf16_f32 v80, v48, v49
    v_cvt_pk_bf16_f32 v81, v50, v51
    global_load_dwordx4 a[224:227], v1, s[48:49] offset:0
    v_exp_f32 v52, v52
    v_exp_f32 v53, v53
    v_exp_f32 v54, v54
    v_exp_f32 v55, v55
    v_mfma_f32_32x32x16_bf16 v[64:79], v[204:207], v[44:47], v[64:79]
    v_cvt_pk_bf16_f32 v82, v52, v53
    v_cvt_pk_bf16_f32 v83, v54, v55
    v_exp_f32 v56, v56
    v_exp_f32 v57, v57
    v_exp_f32 v58, v58
    v_exp_f32 v59, v59
    v_mfma_f32_32x32x16_bf16 v[104:119], v[212:215], v[84:87], v[104:119]
    v_cvt_pk_bf16_f32 v84, v56, v57
    v_cvt_pk_bf16_f32 v85, v58, v59
    buffer_store_dwordx4 v[232:235], v238, s[8:11], s45 offen offset:1024 sc1
    v_exp_f32 v60, v60
    v_exp_f32 v61, v61
    v_exp_f32 v62, v62
    v_exp_f32 v63, v63
    v_mfma_f32_32x32x16_bf16 v[120:135], v[208:211], v[80:83], v[120:135]
    v_cvt_pk_bf16_f32 v86, v60, v61
    v_cvt_pk_bf16_f32 v87, v62, v63
    global_load_dwordx4 a[228:231], v1, s[48:49] offset:1024
    v_exp_f32 v64, v64
    v_exp_f32 v65, v65
    v_exp_f32 v66, v66
    v_exp_f32 v67, v67
    s_waitcnt vmcnt(32)
    v_mfma_f32_32x32x16_bf16 v[48:63], v[152:155], v[16:19], 0
    v_cvt_pk_bf16_f32 v80, v64, v65
    v_cvt_pk_bf16_f32 v81, v66, v67
    global_load_dwordx4 a[232:235], v1, s[48:49] offset:2048
    v_exp_f32 v68, v68
    v_exp_f32 v69, v69
    v_exp_f32 v70, v70
    v_exp_f32 v71, v71
    v_mfma_f32_32x32x16_bf16 v[48:63], v[156:159], v[20:23], v[48:63]
    v_cvt_pk_bf16_f32 v82, v68, v69
    v_cvt_pk_bf16_f32 v83, v70, v71
    v_exp_f32 v72, v72
    v_exp_f32 v73, v73
    v_exp_f32 v74, v74
    v_exp_f32 v75, v75
    v_mfma_f32_32x32x16_bf16 v[120:135], v[212:215], v[84:87], v[120:135]
    v_cvt_pk_bf16_f32 v84, v72, v73
    v_cvt_pk_bf16_f32 v85, v74, v75
    v_exp_f32 v76, v76
    v_exp_f32 v77, v77
    v_exp_f32 v78, v78
    v_exp_f32 v79, v79
    v_mfma_f32_32x32x16_bf16 v[136:151], v[208:211], v[80:83], v[136:151]
    v_cvt_pk_bf16_f32 v86, v76, v77
    v_cvt_pk_bf16_f32 v87, v78, v79
    global_load_dwordx4 a[236:239], v1, s[48:49] offset:3072
    s_mov_b32 s41, s42
    s_mov_b32 s42, s43
    s_mov_b32 s43, s44
    s_mov_b32 s45, s46
    s_mov_b32 s46, s52
    v_mov_b32 v238, v239
    v_mov_b32 v239, v1
    s_add_u32 s60, s60, 8192
    s_addc_u32 s61, s61, 0
    s_add_u32 s62, s62, 8192
    s_addc_u32 s63, s63, 0
    s_add_u32 s29, s29, 1
.p2align 6
L_aa_loop_23:
    v_exp_f32 v48, v48
    v_exp_f32 v49, v49
    v_exp_f32 v50, v50
    v_exp_f32 v51, v51
    v_mfma_f32_32x32x16_bf16 v[64:79], v[152:155], v[24:27], 0
    v_cvt_pk_bf16_f32 v80, v48, v49
    v_cvt_pk_bf16_f32 v81, v50, v51
    v_exp_f32 v52, v52
    v_exp_f32 v53, v53
    v_exp_f32 v54, v54
    v_exp_f32 v55, v55
    v_mfma_f32_32x32x16_bf16 v[64:79], v[156:159], v[28:31], v[64:79]
    v_cvt_pk_bf16_f32 v82, v52, v53
    v_cvt_pk_bf16_f32 v83, v54, v55
    v_exp_f32 v56, v56
    v_exp_f32 v57, v57
    v_exp_f32 v58, v58
    v_exp_f32 v59, v59
    v_mfma_f32_32x32x16_bf16 v[136:151], v[212:215], v[84:87], v[136:151]
    v_cvt_pk_bf16_f32 v84, v56, v57
    v_cvt_pk_bf16_f32 v85, v58, v59
    global_load_dwordx4 v[200:203], v1, s[60:61] offset:-4096
    global_load_dwordx4 v[204:207], v1, s[60:61] offset:-3072
    global_load_dwordx4 v[208:211], v1, s[62:63] offset:-4096
    global_load_dwordx4 v[212:215], v1, s[62:63] offset:-3072
    v_exp_f32 v60, v60
    v_exp_f32 v61, v61
    v_exp_f32 v62, v62
    v_exp_f32 v63, v63
    v_mfma_f32_32x32x16_bf16 v[88:103], v[160:163], v[80:83], v[88:103]
    v_cvt_pk_bf16_f32 v86, v60, v61
    v_cvt_pk_bf16_f32 v87, v62, v63
    v_exp_f32 v64, v64
    v_exp_f32 v65, v65
    v_exp_f32 v66, v66
    v_exp_f32 v67, v67
    v_mfma_f32_32x32x16_bf16 v[48:63], v[152:155], v[32:35], 0
    v_cvt_pk_bf16_f32 v80, v64, v65
    v_cvt_pk_bf16_f32 v81, v66, v67
    v_exp_f32 v68, v68
    v_exp_f32 v69, v69
    v_exp_f32 v70, v70
    v_exp_f32 v71, v71
    v_mfma_f32_32x32x16_bf16 v[48:63], v[156:159], v[36:39], v[48:63]
    v_cvt_pk_bf16_f32 v82, v68, v69
    v_cvt_pk_bf16_f32 v83, v70, v71
    v_exp_f32 v72, v72
    v_exp_f32 v73, v73
    v_exp_f32 v74, v74
    v_exp_f32 v75, v75
    v_mfma_f32_32x32x16_bf16 v[88:103], v[164:167], v[84:87], v[88:103]
    v_cvt_pk_bf16_f32 v84, v72, v73
    v_cvt_pk_bf16_f32 v85, v74, v75
    v_exp_f32 v76, v76
    v_exp_f32 v77, v77
    v_exp_f32 v78, v78
    v_exp_f32 v79, v79
    v_mfma_f32_32x32x16_bf16 v[104:119], v[160:163], v[80:83], v[104:119]
    v_cvt_pk_bf16_f32 v86, v76, v77
    v_cvt_pk_bf16_f32 v87, v78, v79
    v_exp_f32 v48, v48
    v_exp_f32 v49, v49
    v_exp_f32 v50, v50
    v_exp_f32 v51, v51
    v_mfma_f32_32x32x16_bf16 v[64:79], v[152:155], v[40:43], 0
    v_cvt_pk_bf16_f32 v80, v48, v49
    v_cvt_pk_bf16_f32 v81, v50, v51
    v_exp_f32 v52, v52
    v_exp_f32 v53, v53
    v_exp_f32 v54, v54
    v_exp_f32 v55, v55
    v_mfma_f32_32x32x16_bf16 v[64:79], v[156:159], v[44:47], v[64:79]
    v_cvt_pk_bf16_f32 v82, v52, v53
    v_cvt_pk_bf16_f32 v83, v54, v55
    v_exp_f32 v56, v56
    v_exp_f32 v57, v57
    v_exp_f32 v58, v58
    v_exp_f32 v59, v59
    v_mfma_f32_32x32x16_bf16 v[104:119], v[164:167], v[84:87], v[104:119]
    v_cvt_pk_bf16_f32 v84, v56, v57
    v_cvt_pk_bf16_f32 v85, v58, v59
    buffer_store_dwordx4 v[232:235], v1, s[8:11], s41 offen offset:0 sc1
    v_exp_f32 v60, v60
    v_exp_f32 v61, v61
    v_exp_f32 v62, v62
    v_exp_f32 v63, v63
    v_mfma_f32_32x32x16_bf16 v[120:135], v[160:163], v[80:83], v[120:135]
    v_cvt_pk_bf16_f32 v86, v60, v61
    v_cvt_pk_bf16_f32 v87, v62, v63
    v_exp_f32 v64, v64
    v_exp_f32 v65, v65
    v_exp_f32 v66, v66
    v_exp_f32 v67, v67
    s_waitcnt vmcnt(11)
    v_mfma_f32_32x32x16_bf16 v[48:63], v[168:171], v[16:19], 0
    v_cvt_pk_bf16_f32 v80, v64, v65
    v_cvt_pk_bf16_f32 v81, v66, v67
    v_exp_f32 v68, v68
    v_exp_f32 v69, v69
    v_exp_f32 v70, v70
    v_exp_f32 v71, v71
    v_mfma_f32_32x32x16_bf16 v[48:63], v[172:175], v[20:23], v[48:63]
    v_cvt_pk_bf16_f32 v82, v68, v69
    v_cvt_pk_bf16_f32 v83, v70, v71
    v_exp_f32 v72, v72
    v_exp_f32 v73, v73
    v_exp_f32 v74, v74
    v_exp_f32 v75, v75
    v_mfma_f32_32x32x16_bf16 v[120:135], v[164:167], v[84:87], v[120:135]
    v_cvt_pk_bf16_f32 v84, v72, v73
    v_cvt_pk_bf16_f32 v85, v74, v75
    v_exp_f32 v76, v76
    v_exp_f32 v77, v77
    v_exp_f32 v78, v78
    v_exp_f32 v79, v79
    v_mfma_f32_32x32x16_bf16 v[136:151], v[160:163], v[80:83], v[136:151]
    v_cvt_pk_bf16_f32 v86, v76, v77
    v_cvt_pk_bf16_f32 v87, v78, v79
    v_exp_f32 v48, v48
    v_exp_f32 v49, v49
    v_exp_f32 v50, v50
    v_exp_f32 v51, v51
    v_mfma_f32_32x32x16_bf16 v[64:79], v[168:171], v[24:27], 0
    v_cvt_pk_bf16_f32 v80, v48, v49
    v_cvt_pk_bf16_f32 v81, v50, v51
    v_exp_f32 v52, v52
    v_exp_f32 v53, v53
    v_exp_f32 v54, v54
    v_exp_f32 v55, v55
    v_mfma_f32_32x32x16_bf16 v[64:79], v[172:175], v[28:31], v[64:79]
    v_cvt_pk_bf16_f32 v82, v52, v53
    v_cvt_pk_bf16_f32 v83, v54, v55
    v_exp_f32 v56, v56
    v_exp_f32 v57, v57
    v_exp_f32 v58, v58
    v_exp_f32 v59, v59
    v_mfma_f32_32x32x16_bf16 v[136:151], v[164:167], v[84:87], v[136:151]
    v_cvt_pk_bf16_f32 v84, v56, v57
    v_cvt_pk_bf16_f32 v85, v58, v59
    global_load_dwordx4 v[152:155], v1, s[60:61] offset:-2048
    global_load_dwordx4 v[156:159], v1, s[60:61] offset:-1024
    global_load_dwordx4 v[160:163], v1, s[62:63] offset:-2048
    global_load_dwordx4 v[164:167], v1, s[62:63] offset:-1024
    v_exp_f32 v60, v60
    v_exp_f32 v61, v61
    v_exp_f32 v62, v62
    v_exp_f32 v63, v63
    v_mfma_f32_32x32x16_bf16 v[88:103], v[176:179], v[80:83], v[88:103]
    v_cvt_pk_bf16_f32 v86, v60, v61
    v_cvt_pk_bf16_f32 v87, v62, v63
    v_exp_f32 v64, v64
    v_exp_f32 v65, v65
    v_exp_f32 v66, v66
    v_exp_f32 v67, v67
    v_mfma_f32_32x32x16_bf16 v[48:63], v[168:171], v[32:35], 0
    v_cvt_pk_bf16_f32 v80, v64, v65
    v_cvt_pk_bf16_f32 v81, v66, v67
    v_exp_f32 v68, v68
    v_exp_f32 v69, v69
    v_exp_f32 v70, v70
    v_exp_f32 v71, v71
    v_mfma_f32_32x32x16_bf16 v[48:63], v[172:175], v[36:39], v[48:63]
    v_cvt_pk_bf16_f32 v82, v68, v69
    v_cvt_pk_bf16_f32 v83, v70, v71
    v_exp_f32 v72, v72
    v_exp_f32 v73, v73
    v_exp_f32 v74, v74
    v_exp_f32 v75, v75
    v_mfma_f32_32x32x16_bf16 v[88:103], v[180:183], v[84:87], v[88:103]
    v_cvt_pk_bf16_f32 v84, v72, v73
    v_cvt_pk_bf16_f32 v85, v74, v75
    v_exp_f32 v76, v76
    v_exp_f32 v77, v77
    v_exp_f32 v78, v78
    v_exp_f32 v79, v79
    v_mfma_f32_32x32x16_bf16 v[104:119], v[176:179], v[80:83], v[104:119]
    v_cvt_pk_bf16_f32 v86, v76, v77
    v_cvt_pk_bf16_f32 v87, v78, v79
    v_exp_f32 v48, v48
    v_exp_f32 v49, v49
    v_exp_f32 v50, v50
    v_exp_f32 v51, v51
    v_mfma_f32_32x32x16_bf16 v[64:79], v[168:171], v[40:43], 0
    v_cvt_pk_bf16_f32 v80, v48, v49
    v_cvt_pk_bf16_f32 v81, v50, v51
    v_exp_f32 v52, v52
    v_exp_f32 v53, v53
    v_exp_f32 v54, v54
    v_exp_f32 v55, v55
    v_mfma_f32_32x32x16_bf16 v[64:79], v[172:175], v[44:47], v[64:79]
    v_cvt_pk_bf16_f32 v82, v52, v53
    v_cvt_pk_bf16_f32 v83, v54, v55
    v_exp_f32 v56, v56
    v_exp_f32 v57, v57
    v_exp_f32 v58, v58
    v_exp_f32 v59, v59
    v_mfma_f32_32x32x16_bf16 v[104:119], v[180:183], v[84:87], v[104:119]
    v_cvt_pk_bf16_f32 v84, v56, v57
    v_cvt_pk_bf16_f32 v85, v58, v59
    buffer_store_dwordx4 v[232:235], v1, s[8:11], s41 offen offset:1024 sc1
    v_exp_f32 v60, v60
    v_exp_f32 v61, v61
    v_exp_f32 v62, v62
    v_exp_f32 v63, v63
    v_mfma_f32_32x32x16_bf16 v[120:135], v[176:179], v[80:83], v[120:135]
    v_cvt_pk_bf16_f32 v86, v60, v61
    v_cvt_pk_bf16_f32 v87, v62, v63
    v_exp_f32 v64, v64
    v_exp_f32 v65, v65
    v_exp_f32 v66, v66
    v_exp_f32 v67, v67
    s_waitcnt vmcnt(11)
    v_mfma_f32_32x32x16_bf16 v[48:63], v[184:187], v[16:19], 0
    v_cvt_pk_bf16_f32 v80, v64, v65
    v_cvt_pk_bf16_f32 v81, v66, v67
    v_exp_f32 v68, v68
    v_exp_f32 v69, v69
    v_exp_f32 v70, v70
    v_exp_f32 v71, v71
    v_mfma_f32_32x32x16_bf16 v[48:63], v[188:191], v[20:23], v[48:63]
    v_cvt_pk_bf16_f32 v82, v68, v69
    v_cvt_pk_bf16_f32 v83, v70, v71
    v_exp_f32 v72, v72
    v_exp_f32 v73, v73
    v_exp_f32 v74, v74
    v_exp_f32 v75, v75
    v_mfma_f32_32x32x16_bf16 v[120:135], v[180:183], v[84:87], v[120:135]
    v_cvt_pk_bf16_f32 v84, v72, v73
    v_cvt_pk_bf16_f32 v85, v74, v75
    v_exp_f32 v76, v76
    v_exp_f32 v77, v77
    v_exp_f32 v78, v78
    v_exp_f32 v79, v79
    v_mfma_f32_32x32x16_bf16 v[136:151], v[176:179], v[80:83], v[136:151]
    v_cvt_pk_bf16_f32 v86, v76, v77
    v_cvt_pk_bf16_f32 v87, v78, v79
    v_exp_f32 v48, v48
    v_exp_f32 v49, v49
    v_exp_f32 v50, v50
    v_exp_f32 v51, v51
    v_mfma_f32_32x32x16_bf16 v[64:79], v[184:187], v[24:27], 0
    v_cvt_pk_bf16_f32 v80, v48, v49
    v_cvt_pk_bf16_f32 v81, v50, v51
    v_exp_f32 v52, v52
    v_exp_f32 v53, v53
    v_exp_f32 v54, v54
    v_exp_f32 v55, v55
    v_mfma_f32_32x32x16_bf16 v[64:79], v[188:191], v[28:31], v[64:79]
    v_cvt_pk_bf16_f32 v82, v52, v53
    v_cvt_pk_bf16_f32 v83, v54, v55
    v_exp_f32 v56, v56
    v_exp_f32 v57, v57
    v_exp_f32 v58, v58
    v_exp_f32 v59, v59
    v_mfma_f32_32x32x16_bf16 v[136:151], v[180:183], v[84:87], v[136:151]
    v_cvt_pk_bf16_f32 v84, v56, v57
    v_cvt_pk_bf16_f32 v85, v58, v59
    global_load_dwordx4 v[168:171], v1, s[60:61] offset:0
    global_load_dwordx4 v[172:175], v1, s[60:61] offset:1024
    global_load_dwordx4 v[176:179], v1, s[62:63] offset:0
    global_load_dwordx4 v[180:183], v1, s[62:63] offset:1024
    v_exp_f32 v60, v60
    v_exp_f32 v61, v61
    v_exp_f32 v62, v62
    v_exp_f32 v63, v63
    v_mfma_f32_32x32x16_bf16 v[88:103], v[192:195], v[80:83], v[88:103]
    v_cvt_pk_bf16_f32 v86, v60, v61
    v_cvt_pk_bf16_f32 v87, v62, v63
    v_exp_f32 v64, v64
    v_exp_f32 v65, v65
    v_exp_f32 v66, v66
    v_exp_f32 v67, v67
    v_mfma_f32_32x32x16_bf16 v[48:63], v[184:187], v[32:35], 0
    v_cvt_pk_bf16_f32 v80, v64, v65
    v_cvt_pk_bf16_f32 v81, v66, v67
    v_exp_f32 v68, v68
    v_exp_f32 v69, v69
    v_exp_f32 v70, v70
    v_exp_f32 v71, v71
    v_mfma_f32_32x32x16_bf16 v[48:63], v[188:191], v[36:39], v[48:63]
    v_cvt_pk_bf16_f32 v82, v68, v69
    v_cvt_pk_bf16_f32 v83, v70, v71
    v_exp_f32 v72, v72
    v_exp_f32 v73, v73
    v_exp_f32 v74, v74
    v_exp_f32 v75, v75
    v_mfma_f32_32x32x16_bf16 v[88:103], v[196:199], v[84:87], v[88:103]
    v_cvt_pk_bf16_f32 v84, v72, v73
    v_cvt_pk_bf16_f32 v85, v74, v75
    v_exp_f32 v76, v76
    v_exp_f32 v77, v77
    v_exp_f32 v78, v78
    v_exp_f32 v79, v79
    v_mfma_f32_32x32x16_bf16 v[104:119], v[192:195], v[80:83], v[104:119]
    v_cvt_pk_bf16_f32 v86, v76, v77
    v_cvt_pk_bf16_f32 v87, v78, v79
    v_exp_f32 v48, v48
    v_exp_f32 v49, v49
    v_exp_f32 v50, v50
    v_exp_f32 v51, v51
    v_mfma_f32_32x32x16_bf16 v[64:79], v[184:187], v[40:43], 0
    v_cvt_pk_bf16_f32 v80, v48, v49
    v_cvt_pk_bf16_f32 v81, v50, v51
    v_exp_f32 v52, v52
    v_exp_f32 v53, v53
    v_exp_f32 v54, v54
    v_exp_f32 v55, v55
    v_mfma_f32_32x32x16_bf16 v[64:79], v[188:191], v[44:47], v[64:79]
    v_cvt_pk_bf16_f32 v82, v52, v53
    v_cvt_pk_bf16_f32 v83, v54, v55
    v_exp_f32 v56, v56
    v_exp_f32 v57, v57
    v_exp_f32 v58, v58
    v_exp_f32 v59, v59
    v_mfma_f32_32x32x16_bf16 v[104:119], v[196:199], v[84:87], v[104:119]
    v_cvt_pk_bf16_f32 v84, v56, v57
    v_cvt_pk_bf16_f32 v85, v58, v59
    buffer_store_dwordx4 v[232:235], v238, s[8:11], s45 offen offset:0 sc1
    v_exp_f32 v60, v60
    v_exp_f32 v61, v61
    v_exp_f32 v62, v62
    v_exp_f32 v63, v63
    v_mfma_f32_32x32x16_bf16 v[120:135], v[192:195], v[80:83], v[120:135]
    v_cvt_pk_bf16_f32 v86, v60, v61
    v_cvt_pk_bf16_f32 v87, v62, v63
    v_exp_f32 v64, v64
    v_exp_f32 v65, v65
    v_exp_f32 v66, v66
    v_exp_f32 v67, v67
    s_waitcnt vmcnt(11)
    v_mfma_f32_32x32x16_bf16 v[48:63], v[200:203], v[16:19], 0
    v_cvt_pk_bf16_f32 v80, v64, v65
    v_cvt_pk_bf16_f32 v81, v66, v67
    v_exp_f32 v68, v68
    v_exp_f32 v69, v69
    v_exp_f32 v70, v70
    v_exp_f32 v71, v71
    v_mfma_f32_32x32x16_bf16 v[48:63], v[204:207], v[20:23], v[48:63]
    v_cvt_pk_bf16_f32 v82, v68, v69
    v_cvt_pk_bf16_f32 v83, v70, v71
    v_exp_f32 v72, v72
    v_exp_f32 v73, v73
    v_exp_f32 v74, v74
    v_exp_f32 v75, v75
    v_mfma_f32_32x32x16_bf16 v[120:135], v[196:199], v[84:87], v[120:135]
    v_cvt_pk_bf16_f32 v84, v72, v73
    v_cvt_pk_bf16_f32 v85, v74, v75
    v_exp_f32 v76, v76
    v_exp_f32 v77, v77
    v_exp_f32 v78, v78
    v_exp_f32 v79, v79
    v_mfma_f32_32x32x16_bf16 v[136:151], v[192:195], v[80:83], v[136:151]
    v_cvt_pk_bf16_f32 v86, v76, v77
    v_cvt_pk_bf16_f32 v87, v78, v79
    v_exp_f32 v48, v48
    v_exp_f32 v49, v49
    v_exp_f32 v50, v50
    v_exp_f32 v51, v51
    v_mfma_f32_32x32x16_bf16 v[64:79], v[200:203], v[24:27], 0
    v_cvt_pk_bf16_f32 v80, v48, v49
    v_cvt_pk_bf16_f32 v81, v50, v51
    v_exp_f32 v52, v52
    v_exp_f32 v53, v53
    v_exp_f32 v54, v54
    v_exp_f32 v55, v55
    v_mfma_f32_32x32x16_bf16 v[64:79], v[204:207], v[28:31], v[64:79]
    v_cvt_pk_bf16_f32 v82, v52, v53
    v_cvt_pk_bf16_f32 v83, v54, v55
    v_exp_f32 v56, v56
    v_exp_f32 v57, v57
    v_exp_f32 v58, v58
    v_exp_f32 v59, v59
    v_mfma_f32_32x32x16_bf16 v[136:151], v[196:199], v[84:87], v[136:151]
    v_cvt_pk_bf16_f32 v84, v56, v57
    v_cvt_pk_bf16_f32 v85, v58, v59
    global_load_dwordx4 v[184:187], v1, s[60:61] offset:2048
    global_load_dwordx4 v[188:191], v1, s[60:61] offset:3072
    global_load_dwordx4 v[192:195], v1, s[62:63] offset:2048
    global_load_dwordx4 v[196:199], v1, s[62:63] offset:3072
    v_exp_f32 v60, v60
    v_exp_f32 v61, v61
    v_exp_f32 v62, v62
    v_exp_f32 v63, v63
    v_mfma_f32_32x32x16_bf16 v[88:103], v[208:211], v[80:83], v[88:103]
    v_cvt_pk_bf16_f32 v86, v60, v61
    v_cvt_pk_bf16_f32 v87, v62, v63
    v_exp_f32 v64, v64
    v_exp_f32 v65, v65
    v_exp_f32 v66, v66
    v_exp_f32 v67, v67
    v_mfma_f32_32x32x16_bf16 v[48:63], v[200:203], v[32:35], 0
    v_cvt_pk_bf16_f32 v80, v64, v65
    v_cvt_pk_bf16_f32 v81, v66, v67
    v_exp_f32 v68, v68
    v_exp_f32 v69, v69
    v_exp_f32 v70, v70
    v_exp_f32 v71, v71
    v_mfma_f32_32x32x16_bf16 v[48:63], v[204:207], v[36:39], v[48:63]
    v_cvt_pk_bf16_f32 v82, v68, v69
    v_cvt_pk_bf16_f32 v83, v70, v71
    v_exp_f32 v72, v72
    v_exp_f32 v73, v73
    v_exp_f32 v74, v74
    v_exp_f32 v75, v75
    v_mfma_f32_32x32x16_bf16 v[88:103], v[212:215], v[84:87], v[88:103]
    v_cvt_pk_bf16_f32 v84, v72, v73
    v_cvt_pk_bf16_f32 v85, v74, v75
    v_exp_f32 v76, v76
    v_exp_f32 v77, v77
    v_exp_f32 v78, v78
    v_exp_f32 v79, v79
    v_mfma_f32_32x32x16_bf16 v[104:119], v[208:211], v[80:83], v[104:119]
    v_cvt_pk_bf16_f32 v86, v76, v77
    v_cvt_pk_bf16_f32 v87, v78, v79
    v_exp_f32 v48, v48
    v_exp_f32 v49, v49
    v_exp_f32 v50, v50
    v_exp_f32 v51, v51
    v_mfma_f32_32x32x16_bf16 v[64:79], v[200:203], v[40:43], 0
    v_cvt_pk_bf16_f32 v80, v48, v49
    v_cvt_pk_bf16_f32 v81, v50, v51
    v_exp_f32 v52, v52
    v_exp_f32 v53, v53
    v_exp_f32 v54, v54
    v_exp_f32 v55, v55
    v_mfma_f32_32x32x16_bf16 v[64:79], v[204:207], v[44:47], v[64:79]
    v_cvt_pk_bf16_f32 v82, v52, v53
    v_cvt_pk_bf16_f32 v83, v54, v55
    v_exp_f32 v56, v56
    v_exp_f32 v57, v57
    v_exp_f32 v58, v58
    v_exp_f32 v59, v59
    v_mfma_f32_32x32x16_bf16 v[104:119], v[212:215], v[84:87], v[104:119]
    v_cvt_pk_bf16_f32 v84, v56, v57
    v_cvt_pk_bf16_f32 v85, v58, v59
    buffer_store_dwordx4 v[232:235], v238, s[8:11], s45 offen offset:1024 sc1
    v_exp_f32 v60, v60
    v_exp_f32 v61, v61
    v_exp_f32 v62, v62
    v_exp_f32 v63, v63
    v_mfma_f32_32x32x16_bf16 v[120:135], v[208:211], v[80:83], v[120:135]
    v_cvt_pk_bf16_f32 v86, v60, v61
    v_cvt_pk_bf16_f32 v87, v62, v63
    v_exp_f32 v64, v64
    v_exp_f32 v65, v65
    v_exp_f32 v66, v66
    v_exp_f32 v67, v67
    s_waitcnt vmcnt(11)
    v_mfma_f32_32x32x16_bf16 v[48:63], v[152:155], v[16:19], 0
    v_cvt_pk_bf16_f32 v80, v64, v65
    v_cvt_pk_bf16_f32 v81, v66, v67
    v_exp_f32 v68, v68
    v_exp_f32 v69, v69
    v_exp_f32 v70, v70
    v_exp_f32 v71, v71
    v_mfma_f32_32x32x16_bf16 v[48:63], v[156:159], v[20:23], v[48:63]
    v_cvt_pk_bf16_f32 v82, v68, v69
    v_cvt_pk_bf16_f32 v83, v70, v71
    v_exp_f32 v72, v72
    v_exp_f32 v73, v73
    v_exp_f32 v74, v74
    v_exp_f32 v75, v75
    v_mfma_f32_32x32x16_bf16 v[120:135], v[212:215], v[84:87], v[120:135]
    v_cvt_pk_bf16_f32 v84, v72, v73
    v_cvt_pk_bf16_f32 v85, v74, v75
    v_exp_f32 v76, v76
    v_exp_f32 v77, v77
    v_exp_f32 v78, v78
    v_exp_f32 v79, v79
    v_mfma_f32_32x32x16_bf16 v[136:151], v[208:211], v[80:83], v[136:151]
    v_cvt_pk_bf16_f32 v86, v76, v77
    v_cvt_pk_bf16_f32 v87, v78, v79
    s_mov_b32 s41, s42
    s_mov_b32 s42, s43
    s_mov_b32 s43, s44
    s_mov_b32 s45, s46
    s_mov_b32 s46, s52
    v_mov_b32 v238, v239
    v_mov_b32 v239, v1
    s_add_u32 s60, s60, 8192
    s_addc_u32 s61, s61, 0
    s_add_u32 s62, s62, 8192
    s_addc_u32 s63, s63, 0
    s_add_u32 s29, s29, 1
    s_cmp_lt_u32 s29, 4
    s_cbranch_scc1 L_aa_loop_23
    s_mul_i32 s57, s57, 24
    s_mul_i32 s58, s58, 24
    v_mfma_f32_32x32x16_bf16 v[136:151], v[212:215], v[84:87], v[136:151]
    s_mul_i32 s59, s59, 24
    v_add_u32 v219, 86016, v1
    v_add_u32 v216, s57, v219
    v_add_u32 v217, s58, v219
    v_add_u32 v218, s59, v219
    s_mul_i32 s20, s3, 12288
    v_add_u32 v219, s20, v219
    s_lshl_b32 s21, s7, 7
    s_lshl_b32 s22, s3, 2
    s_add_u32 s21, s21, s22
    s_add_u32 s21, s21, s30
    s_add_u32 s21, s21, 524288
    s_mov_b32 s20, 0x17800000
    ds_write_b128 v216, v[104:107] offset:0
    ds_write_b128 v216, v[108:111] offset:1024
    ds_write_b128 v216, v[112:115] offset:2048
    ds_write_b128 v216, v[116:119] offset:3072
    ds_write_b128 v217, v[120:123] offset:4096
    ds_write_b128 v217, v[124:127] offset:5120
    ds_write_b128 v217, v[128:131] offset:6144
    ds_write_b128 v217, v[132:135] offset:7168
    ds_write_b128 v218, v[136:139] offset:8192
    ds_write_b128 v218, v[140:143] offset:9216
    ds_write_b128 v218, v[144:147] offset:10240
    ds_write_b128 v218, v[148:151] offset:11264
    s_waitcnt vmcnt(0) lgkmcnt(0)
    s_barrier
    ds_read_b32 v48, v225 offset:0
    ds_read_b32 v49, v225 offset:128
    ds_read_b32 v50, v225 offset:256
    ds_read_b32 v51, v225 offset:384
    ds_read_b128 v[152:155], v219 offset:0
    ds_read_b128 v[156:159], v219 offset:1024
    ds_read_b128 v[160:163], v219 offset:2048
    ds_read_b128 v[164:167], v219 offset:3072
    ds_read_b128 v[168:171], v219 offset:4096
    ds_read_b128 v[172:175], v219 offset:5120
    ds_read_b128 v[176:179], v219 offset:6144
    ds_read_b128 v[180:183], v219 offset:7168
    ds_read_b128 v[184:187], v219 offset:8192
    ds_read_b128 v[188:191], v219 offset:9216
    ds_read_b128 v[192:195], v219 offset:10240
    ds_read_b128 v[196:199], v219 offset:11264
    v_mov_b32 v221, 0
    s_waitcnt lgkmcnt(12)
    v_max3_f32 v222, v48, v49, v50
    v_max_f32 v222, v222, v51
    v_sub_f32 v48, v48, v222
    v_sub_f32 v49, v49, v222
    v_sub_f32 v50, v50, v222
    v_sub_f32 v51, v51, v222
    v_exp_f32 v48, v48
    v_exp_f32 v49, v49
    v_exp_f32 v50, v50
    v_exp_f32 v51, v51
    v_mul_f32 v88, v48, v88
    v_mul_f32 v89, v48, v89
    v_mul_f32 v90, v48, v90
    v_mul_f32 v91, v48, v91
    v_mul_f32 v92, v48, v92
    v_mul_f32 v93, v48, v93
    v_mul_f32 v94, v48, v94
    v_mul_f32 v95, v48, v95
    v_mul_f32 v96, v48, v96
    v_mul_f32 v97, v48, v97
    v_mul_f32 v98, v48, v98
    v_mul_f32 v99, v48, v99
    v_mul_f32 v100, v48, v100
    v_mul_f32 v101, v48, v101
    v_mul_f32 v102, v48, v102
    v_mul_f32 v103, v48, v103
    s_waitcnt lgkmcnt(8)
    v_fmac_f32 v88, v49, v152
    v_fmac_f32 v89, v49, v153
    v_fmac_f32 v90, v49, v154
    v_fmac_f32 v91, v49, v155
    v_fmac_f32 v92, v49, v156
    v_fmac_f32 v93, v49, v157
    v_fmac_f32 v94, v49, v158
    v_fmac_f32 v95, v49, v159
    v_fmac_f32 v96, v49, v160
    v_fmac_f32 v97, v49, v161
    v_fmac_f32 v98, v49, v162
    v_fmac_f32 v99, v49, v163
    v_fmac_f32 v100, v49, v164
    v_fmac_f32 v101, v49, v165
    v_fmac_f32 v102, v49, v166
    v_fmac_f32 v103, v49, v167
    s_waitcnt lgkmcnt(4)
    v_fmac_f32 v88, v50, v168
    v_fmac_f32 v89, v50, v169
    v_fmac_f32 v90, v50, v170
    v_fmac_f32 v91, v50, v171
    v_fmac_f32 v92, v50, v172
    v_fmac_f32 v93, v50, v173
    v_fmac_f32 v94, v50, v174
    v_fmac_f32 v95, v50, v175
    v_fmac_f32 v96, v50, v176
    v_fmac_f32 v97, v50, v177
    v_fmac_f32 v98, v50, v178
    v_fmac_f32 v99, v50, v179
    v_fmac_f32 v100, v50, v180
    v_fmac_f32 v101, v50, v181
    v_fmac_f32 v102, v50, v182
    v_fmac_f32 v103, v50, v183
    s_waitcnt lgkmcnt(0)
    v_fmac_f32 v88, v51, v184
    v_fmac_f32 v89, v51, v185
    v_fmac_f32 v90, v51, v186
    v_fmac_f32 v91, v51, v187
    v_fmac_f32 v92, v51, v188
    v_fmac_f32 v93, v51, v189
    v_fmac_f32 v94, v51, v190
    v_fmac_f32 v95, v51, v191
    v_fmac_f32 v96, v51, v192
    v_fmac_f32 v97, v51, v193
    v_fmac_f32 v98, v51, v194
    v_fmac_f32 v99, v51, v195
    v_fmac_f32 v100, v51, v196
    v_fmac_f32 v101, v51, v197
    v_fmac_f32 v102, v51, v198
    v_fmac_f32 v103, v51, v199
    v_mov_b32 v218, v100
    v_mov_b32 v219, v100
    v_pk_add_f32 v[222:223], v[88:89], v[90:91]
    v_pk_add_f32 v[226:227], v[92:93], v[94:95]
    v_permlane32_swap_b32 v218, v219
    v_pk_add_f32 v[222:223], v[222:223], v[96:97]
    v_pk_add_f32 v[226:227], v[226:227], v[98:99]
    v_pk_add_f32 v[222:223], v[222:223], v[100:101]
    v_pk_add_f32 v[226:227], v[226:227], v[102:103]
    v_pk_add_f32 v[222:223], v[222:223], v[226:227]
    v_cmp_gt_f32 vcc, s20, v219
    v_cmp_u_f32 s[24:25], v222, v223
    v_rcp_f32 v218, v219
    s_or_b64 vcc, vcc, s[24:25]
    s_cmp_lg_u64 vcc, 0
    s_cbranch_scc1 L_aa_slow_25
L_aa_norm_24:
    v_mul_f32 v88, v218, v88
    v_mul_f32 v89, v218, v89
    v_mul_f32 v90, v218, v90
    v_mul_f32 v91, v218, v91
    v_mul_f32 v92, v218, v92
    v_mul_f32 v93, v218, v93
    v_mul_f32 v94, v218, v94
    v_mul_f32 v95, v218, v95
    v_mul_f32 v96, v218, v96
    v_mul_f32 v97, v218, v97
    v_mul_f32 v98, v218, v98
    v_mul_f32 v99, v218, v99
    v_mul_f32 v100, v218, v100
    v_mul_f32 v101, v218, v101
    v_mul_f32 v102, v218, v102
    v_mul_f32 v103, v218, v103
    v_cvt_pk_bf16_f32 v80, v88, v89
    v_cvt_pk_bf16_f32 v81, v90, v91
    v_cvt_pk_bf16_f32 v82, v92, v93
    v_cvt_pk_bf16_f32 v83, v94, v95
    v_cvt_pk_bf16_f32 v84, v96, v97
    v_cvt_pk_bf16_f32 v85, v98, v99
    v_cvt_pk_bf16_f32 v86, v100, v101
    v_cvt_pk_bf16_f32 v87, v102, v103
    v_min_u32 v80, s54, v80
    v_min_u32 v81, s54, v81
    v_min_u32 v82, s54, v82
    v_min_u32 v83, s54, v83
    v_min_u32 v84, s54, v84
    v_min_u32 v85, s54, v85
    v_min_u32 v86, s54, v86
    v_min_u32 v87, s54, v87
    buffer_store_dwordx4 v[80:83], v237, s[8:11], s56 offen sc1
    buffer_store_dwordx4 v[84:87], v237, s[8:11], s56 offen offset:1024 sc1
    s_mov_b64 exec, 1
    buffer_store_dword v221, v221, s[8:11], s21 offen sc1
    s_mov_b64 exec, -1
    s_barrier
    s_lshl_b32 s21, s31, 9
    s_add_u32 s21, s21, s30
    s_add_u32 s21, s21, 524288
    v_lshrrev_b32 v177, 2, v2
    v_and_b32 v177, 3, v177
    v_lshlrev_b32 v177, 7, v177
    v_and_b32 v178, 3, v2
    v_lshl_add_u32 v177, v178, 2, v177
    s_lshl_b32 s20, s31, 15
    s_lshl_b32 s22, s3, 13
    s_add_u32 s20, s20, s22
    s_add_u32 s20, s20, s30
    s_add_u32 s20, s20, 5046272
    s_mov_b32 s27, s20
    s_add_u32 s22, s22, 86016
    v_add_u32 v176, s22, v1
    v_add_u32 v179, 86016, v1
    s_cmp_lg_u32 s33, 0
    s_cbranch_scc1 L_aa_nowb_30
    s_mul_i32 s44, s5, 86016
    s_mul_i32 s45, s3, 21504
    s_add_u32 s44, s44, s45
    s_add_u32 s44, s44, 1376256
    s_mov_b32 m0, s45
    s_nop 0
    buffer_load_dwordx4 v1, s[8:11], s44 offen offset:0 lds
    buffer_load_dwordx4 v1, s[8:11], s44 offen offset:1024 lds
    buffer_load_dwordx4 v1, s[8:11], s44 offen offset:2048 lds
    buffer_load_dwordx4 v1, s[8:11], s44 offen offset:3072 lds
    s_add_u32 s44, s44, 4096
    s_add_u32 s45, s45, 4096
    s_mov_b32 m0, s45
    s_nop 0
    buffer_load_dwordx4 v1, s[8:11], s44 offen offset:0 lds
    buffer_load_dwordx4 v1, s[8:11], s44 offen offset:1024 lds
    buffer_load_dwordx4 v1, s[8:11], s44 offen offset:2048 lds
    buffer_load_dwordx4 v1, s[8:11], s44 offen offset:3072 lds
    s_add_u32 s44, s44, 4096
    s_add_u32 s45, s45, 4096
    s_mov_b32 m0, s45
    s_nop 0
    buffer_load_dwordx4 v1, s[8:11], s44 offen offset:0 lds
    buffer_load_dwordx4 v1, s[8:11], s44 offen offset:1024 lds
    buffer_load_dwordx4 v1, s[8:11], s44 offen offset:2048 lds
    buffer_load_dwordx4 v1, s[8:11], s44 offen offset:3072 lds
    s_add_u32 s44, s44, 4096
    s_add_u32 s45, s45, 4096
    s_mov_b32 m0, s45
    s_nop 0
    buffer_load_dwordx4 v1, s[8:11], s44 offen offset:0 lds
    buffer_load_dwordx4 v1, s[8:11], s44 offen offset:1024 lds
    buffer_load_dwordx4 v1, s[8:11], s44 offen offset:2048 lds
    buffer_load_dwordx4 v1, s[8:11], s44 offen offset:3072 lds
    s_add_u32 s44, s44, 4096
    s_add_u32 s45, s45, 4096
    s_mov_b32 m0, s45
    s_nop 0
    buffer_load_dwordx4 v1, s[8:11], s44 offen offset:0 lds
    buffer_load_dwordx4 v1, s[8:11], s44 offen offset:1024 lds
    buffer_load_dwordx4 v1, s[8:11], s44 offen offset:2048 lds
    buffer_load_dwordx4 v1, s[8:11], s44 offen offset:3072 lds
    s_add_u32 s44, s44, 4096
    s_add_u32 s45, s45, 4096
    s_mov_b32 m0, s45
    s_nop 0
    buffer_load_dwordx4 v1, s[8:11], s44 offen offset:0 lds
L_aa_nowb_30:
    s_mov_b32 s35, 0
L_ho_31:
    buffer_load_dword v178, v177, s[8:11], s21 offen sc1
    s_waitcnt vmcnt(0)
    v_cmp_eq_u32 vcc, -1, v178
    s_nop 1
    s_cmp_lg_u64 vcc, 0
    s_cbranch_scc1 L_ho_r_32
L_ho_ok_33:
    s_mov_b32 m0, s22
    s_nop 0
    buffer_load_dwordx4 v1, s[8:11], s20 offen offset:0 lds
    buffer_load_dwordx4 v1, s[8:11], s20 offen offset:1024 lds
    buffer_load_dwordx4 v1, s[8:11], s20 offen offset:2048 lds
    buffer_load_dwordx4 v1, s[8:11], s20 offen offset:3072 lds
    s_add_u32 s29, s20, 4096
    s_add_u32 s25, s22, 4096
    s_mov_b32 m0, s25
    s_nop 0
    buffer_load_dwordx4 v1, s[8:11], s29 offen offset:0 lds
    buffer_load_dwordx4 v1, s[8:11], s29 offen offset:1024 lds
    buffer_load_dwordx4 v1, s[8:11], s29 offen offset:2048 lds
    buffer_load_dwordx4 v1, s[8:11], s29 offen offset:3072 lds
    v_lshlrev_b32 v160, 16, v240
    v_and_b32 v161, 0xffff0000, v240
    v_lshlrev_b32 v162, 16, v241
    v_and_b32 v163, 0xffff0000, v241
    v_lshlrev_b32 v164, 16, v242
    v_and_b32 v165, 0xffff0000, v242
    v_lshlrev_b32 v166, 16, v243
    v_and_b32 v167, 0xffff0000, v243
    v_lshlrev_b32 v168, 16, v244
    v_and_b32 v169, 0xffff0000, v244
    v_lshlrev_b32 v170, 16, v245
    v_and_b32 v171, 0xffff0000, v245
    v_lshlrev_b32 v172, 16, v246
    v_and_b32 v173, 0xffff0000, v246
    v_lshlrev_b32 v174, 16, v247
    v_and_b32 v175, 0xffff0000, v247
    s_mov_b32 s53, 0
    s_waitcnt vmcnt(0)
    s_barrier
L_op_mm_35:
    ds_read_b128 v[16:19], v179 offset:0
    ds_read_b128 v[20:23], v179 offset:1024
    ds_read_b128 v[24:27], v179 offset:2048
    ds_read_b128 v[28:31], v179 offset:3072
    ds_read_b128 v[32:35], v179 offset:4096
    ds_read_b128 v[36:39], v179 offset:5120
    ds_read_b128 v[40:43], v179 offset:6144
    ds_read_b128 v[44:47], v179 offset:7168
    ds_read_b128 v[48:51], v179 offset:8192
    ds_read_b128 v[52:55], v179 offset:9216
    ds_read_b128 v[56:59], v179 offset:10240
    ds_read_b128 v[60:63], v179 offset:11264
    ds_read_b128 v[64:67], v179 offset:12288
    ds_read_b128 v[68:71], v179 offset:13312
    ds_read_b128 v[72:75], v179 offset:14336
    ds_read_b128 v[76:79], v179 offset:15360
    ds_read_b128 v[80:83], v179 offset:16384
    ds_read_b128 v[84:87], v179 offset:17408
    ds_read_b128 v[88:91], v179 offset:18432
    ds_read_b128 v[92:95], v179 offset:19456
    ds_read_b128 v[96:99], v179 offset:20480
    ds_read_b128 v[100:103], v179 offset:21504
    ds_read_b128 v[104:107], v179 offset:22528
    ds_read_b128 v[108:111], v179 offset:23552
    ds_read_b128 v[112:115], v179 offset:24576
    ds_read_b128 v[116:119], v179 offset:25600
    ds_read_b128 v[120:123], v179 offset:26624
    ds_read_b128 v[124:127], v179 offset:27648
    ds_read_b128 v[128:131], v179 offset:28672
    ds_read_b128 v[132:135], v179 offset:29696
    ds_read_b128 v[136:139], v179 offset:30720
    ds_read_b128 v[140:143], v179 offset:31744
    s_waitcnt lgkmcnt(15)
    v_mfma_f32_32x32x16_bf16 v[144:159], a[112:115], v[16:19], v[160:175]
    s_waitcnt lgkmcnt(15)
    v_mfma_f32_32x32x16_bf16 v[144:159], a[116:119], v[20:23], v[144:159]
    s_waitcnt lgkmcnt(15)
    v_mfma_f32_32x32x16_bf16 v[144:159], a[120:123], v[24:27], v[144:159]
    s_waitcnt lgkmcnt(15)
    v_mfma_f32_32x32x16_bf16 v[144:159], a[124:127], v[28:31], v[144:159]
    s_waitcnt lgkmcnt(15)
    v_mfma_f32_32x32x16_bf16 v[144:159], a[128:131], v[32:35], v[144:159]
    s_waitcnt lgkmcnt(15)
    v_mfma_f32_32x32x16_bf16 v[144:159], a[132:135], v[36:39], v[144:159]
    s_waitcnt lgkmcnt(15)
    v_mfma_f32_32x32x16_bf16 v[144:159], a[136:139], v[40:43], v[144:159]
    s_waitcnt lgkmcnt(15)
    v_mfma_f32_32x32x16_bf16 v[144:159], a[140:143], v[44:47], v[144:159]
    s_waitcnt lgkmcnt(15)
    v_mfma_f32_32x32x16_bf16 v[144:159], a[144:147], v[48:51], v[144:159]
    s_waitcnt lgkmcnt(15)
    v_mfma_f32_32x32x16_bf16 v[144:159], a[148:151], v[52:55], v[144:159]
    s_waitcnt lgkmcnt(15)
    v_mfma_f32_32x32x16_bf16 v[144:159], a[152:155], v[56:59], v[144:159]
    s_waitcnt lgkmcnt(15)
    v_mfma_f32_32x32x16_bf16 v[144:159], a[156:159], v[60:63], v[144:159]
    s_waitcnt lgkmcnt(15)
    v_mfma_f32_32x32x16_bf16 v[144:159], a[160:163], v[64:67], v[144:159]
    s_waitcnt lgkmcnt(15)
    v_mfma_f32_32x32x16_bf16 v[144:159], a[164:167], v[68:71], v[144:159]
    s_waitcnt lgkmcnt(15)
    v_mfma_f32_32x32x16_bf16 v[144:159], a[168:171], v[72:75], v[144:159]
    s_waitcnt lgkmcnt(15)
    v_mfma_f32_32x32x16_bf16 v[144:159], a[172:175], v[76:79], v[144:159]
    s_waitcnt lgkmcnt(15)
    v_mfma_f32_32x32x16_bf16 v[144:159], a[176:179], v[80:83], v[144:159]
    s_waitcnt lgkmcnt(14)
    v_mfma_f32_32x32x16_bf16 v[144:159], a[180:183], v[84:87], v[144:159]
    s_waitcnt lgkmcnt(13)
    v_mfma_f32_32x32x16_bf16 v[144:159], a[184:187], v[88:91], v[144:159]
    s_waitcnt lgkmcnt(12)
    v_mfma_f32_32x32x16_bf16 v[144:159], a[188:191], v[92:95], v[144:159]
    s_waitcnt lgkmcnt(11)
    v_mfma_f32_32x32x16_bf16 v[144:159], a[192:195], v[96:99], v[144:159]
    s_waitcnt lgkmcnt(10)
    v_mfma_f32_32x32x16_bf16 v[144:159], a[196:199], v[100:103], v[144:159]
    s_waitcnt lgkmcnt(9)
    v_mfma_f32_32x32x16_bf16 v[144:159], a[200:203], v[104:107], v[144:159]
    s_waitcnt lgkmcnt(8)
    v_mfma_f32_32x32x16_bf16 v[144:159], a[204:207], v[108:111], v[144:159]
    s_waitcnt lgkmcnt(7)
    v_mfma_f32_32x32x16_bf16 v[144:159], a[208:211], v[112:115], v[144:159]
    s_waitcnt lgkmcnt(6)
    v_mfma_f32_32x32x16_bf16 v[144:159], a[212:215], v[116:119], v[144:159]
    s_waitcnt lgkmcnt(5)
    v_mfma_f32_32x32x16_bf16 v[144:159], a[216:219], v[120:123], v[144:159]
    s_waitcnt lgkmcnt(4)
    v_mfma_f32_32x32x16_bf16 v[144:159], a[220:223], v[124:127], v[144:159]
    s_waitcnt lgkmcnt(3)
    v_mfma_f32_32x32x16_bf16 v[144:159], a[224:227], v[128:131], v[144:159]
    s_waitcnt lgkmcnt(2)
    v_mfma_f32_32x32x16_bf16 v[144:159], a[228:231], v[132:135], v[144:159]
    s_waitcnt lgkmcnt(1)
    v_mfma_f32_32x32x16_bf16 v[144:159], a[232:235], v[136:139], v[144:159]
    s_waitcnt lgkmcnt(0)
    v_mfma_f32_32x32x16_bf16 v[144:159], a[236:239], v[140:143], v[144:159]
    s_mul_i32 s20, s31, 28672
    s_lshl_b32 s21, s32, 11
    s_add_u32 s20, s20, s21
    s_add_u32 s20, s20, s30
    s_add_u32 s20, s20, 7143424
    s_lshl_b32 s21, s31, 12
    s_lshl_b32 s22, s32, 8
    s_add_u32 s21, s21, s22
    s_add_u32 s21, s21, s30
    s_add_u32 s21, s21, 262144
    s_mov_b32 s22, 0x3f803f80
    v_lshlrev_b32 v182, 3, v2
    s_nop 1
    v_cmp_u_f32 vcc, v144, v144
    s_nop 1
    s_cmp_lg_u64 vcc, 0
    s_cbranch_scc1 L_op_redo_36
L_op_ok_37:
    s_cmp_ge_u32 s32, 14
    s_cbranch_scc1 L_op_skip_34
    v_mov_b32 v176, 0
    v_mov_b32 v177, 0
    v_cvt_pk_bf16_f32 v240, v144, v145
    v_cvt_pk_bf16_f32 v241, v146, v147
    v_cvt_pk_bf16_f32 v242, v148, v149
    v_cvt_pk_bf16_f32 v243, v150, v151
    v_cvt_pk_bf16_f32 v244, v152, v153
    v_cvt_pk_bf16_f32 v245, v154, v155
    v_cvt_pk_bf16_f32 v246, v156, v157
    v_cvt_pk_bf16_f32 v247, v158, v159
    v_min_u32 v240, s54, v240
    v_min_u32 v241, s54, v241
    v_min_u32 v242, s54, v242
    v_min_u32 v243, s54, v243
    v_min_u32 v244, s54, v244
    v_min_u32 v245, s54, v245
    v_min_u32 v246, s54, v246
    v_min_u32 v247, s54, v247
    buffer_store_dwordx4 v[240:243], v1, s[8:11], s20 offen sc1
    buffer_store_dwordx4 v[244:247], v1, s[8:11], s20 offen offset:1024 sc1
    v_dot2_f32_bf16 v176, v240, s22, v176
    v_dot2_f32_bf16 v177, v240, v240, v177
    v_dot2_f32_bf16 v176, v241, s22, v176
    v_dot2_f32_bf16 v177, v241, v241, v177
    v_dot2_f32_bf16 v176, v242, s22, v176
    v_dot2_f32_bf16 v177, v242, v242, v177
    v_dot2_f32_bf16 v176, v243, s22, v176
    v_dot2_f32_bf16 v177, v243, v243, v177
    v_dot2_f32_bf16 v176, v244, s22, v176
    v_dot2_f32_bf16 v177, v244, v244, v177
    v_dot2_f32_bf16 v176, v245, s22, v176
    v_dot2_f32_bf16 v177, v245, v245, v177
    v_dot2_f32_bf16 v176, v246, s22, v176
    v_dot2_f32_bf16 v177, v246, v246, v177
    v_dot2_f32_bf16 v176, v247, s22, v176
    v_dot2_f32_bf16 v177, v247, v247, v177
    s_nop 3
    v_mov_b32 v178, v176
    v_mov_b32 v179, v177
    s_nop 1
    v_permlane32_swap_b32 v176, v178
    v_permlane32_swap_b32 v177, v179
    s_nop 1
    v_add_f32 v176, v176, v178
    v_add_f32 v177, v177, v179
    v_min_u32 v176, s54, v176
    v_min_u32 v177, s54, v177
    s_mov_b32 exec_hi, 0
    buffer_store_dwordx2 v[176:177], v182, s[8:11], s21 offen sc1
    s_mov_b64 exec, -1
L_op_skip_34:
    s_barrier
    s_mul_i32 s21, s5, 384
    s_add_u32 s21, s21, 2756608
    v_lshlrev_b32 v249, 4, v3
    v_lshlrev_b32 v250, 2, v2
    buffer_load_dwordx4 v[192:195], v249, s[8:11], s21 offen offset:0
    buffer_load_dwordx4 v[196:199], v249, s[8:11], s21 offen offset:32
    buffer_load_dwordx4 v[200:203], v249, s[8:11], s21 offen offset:64
    buffer_load_dwordx4 v[204:207], v249, s[8:11], s21 offen offset:96
    buffer_load_dwordx4 v[208:211], v249, s[8:11], s21 offen offset:128
    buffer_load_dwordx4 v[212:215], v249, s[8:11], s21 offen offset:160
    buffer_load_dwordx4 v[216:219], v249, s[8:11], s21 offen offset:192
    buffer_load_dwordx4 v[220:223], v249, s[8:11], s21 offen offset:224
    buffer_load_dword v251, v250, s[8:11], s21 offen offset:256
    v_mul_u32_u24 v248, 1792, v3
    v_lshl_add_u32 v248, v2, 3, v248
    s_lshl_b32 s20, s6, 12
    s_add_u32 s20, s20, s30
    s_add_u32 s20, s20, 262144
    s_mov_b32 s35, 0
L_st_42:
    buffer_load_dwordx2 v[128:129], v248, s[8:11], s20 offen offset:0 sc1
    buffer_load_dwordx2 v[130:131], v248, s[8:11], s20 offen offset:256 sc1
    buffer_load_dwordx2 v[132:133], v248, s[8:11], s20 offen offset:512 sc1
    buffer_load_dwordx2 v[134:135], v248, s[8:11], s20 offen offset:768 sc1
    buffer_load_dwordx2 v[136:137], v248, s[8:11], s20 offen offset:1024 sc1
    buffer_load_dwordx2 v[138:139], v248, s[8:11], s20 offen offset:1280 sc1
    buffer_load_dwordx2 v[140:141], v248, s[8:11], s20 offen offset:1536 sc1
    s_waitcnt vmcnt(0)
    v_max3_u32 v249, v128, v129, v130
    v_max3_u32 v249, v249, v131, v132
    v_max3_u32 v249, v249, v133, v134
    v_max3_u32 v249, v249, v135, v136
    v_max3_u32 v249, v249, v137, v138
    v_max3_u32 v249, v249, v139, v140
    v_max_u32 v249, v249, v141
    v_cmp_eq_u32 vcc, -1, v249
    s_nop 1
    s_cmp_lg_u64 vcc, 0
    s_cbranch_scc1 L_st_r_43
L_st_ok_44:
    s_mul_i32 s21, s6, 28672
    s_add_u32 s21, s21, s30
    s_add_u32 s21, s21, 7143424
    s_mov_b32 s35, 0
    buffer_load_dwordx4 v[16:19], v1, s[8:11], s21 offen offset:0
    buffer_load_dwordx4 v[20:23], v1, s[8:11], s21 offen offset:1024
    buffer_load_dwordx4 v[24:27], v1, s[8:11], s21 offen offset:2048
    buffer_load_dwordx4 v[28:31], v1, s[8:11], s21 offen offset:3072
    s_add_u32 s29, s21, 4096
    buffer_load_dwordx4 v[32:35], v1, s[8:11], s29 offen offset:0
    buffer_load_dwordx4 v[36:39], v1, s[8:11], s29 offen offset:1024
    buffer_load_dwordx4 v[40:43], v1, s[8:11], s29 offen offset:2048
    buffer_load_dwordx4 v[44:47], v1, s[8:11], s29 offen offset:3072
    s_add_u32 s29, s21, 8192
    buffer_load_dwordx4 v[48:51], v1, s[8:11], s29 offen offset:0
    buffer_load_dwordx4 v[52:55], v1, s[8:11], s29 offen offset:1024
    buffer_load_dwordx4 v[56:59], v1, s[8:11], s29 offen offset:2048
    buffer_load_dwordx4 v[60:63], v1, s[8:11], s29 offen offset:3072
    s_add_u32 s29, s21, 12288
    buffer_load_dwordx4 v[64:67], v1, s[8:11], s29 offen offset:0
    buffer_load_dwordx4 v[68:71], v1, s[8:11], s29 offen offset:1024
    buffer_load_dwordx4 v[72:75], v1, s[8:11], s29 offen offset:2048
    buffer_load_dwordx4 v[76:79], v1, s[8:11], s29 offen offset:3072
    s_add_u32 s29, s21, 16384
    buffer_load_dwordx4 v[80:83], v1, s[8:11], s29 offen offset:0
    buffer_load_dwordx4 v[84:87], v1, s[8:11], s29 offen offset:1024
    buffer_load_dwordx4 v[88:91], v1, s[8:11], s29 offen offset:2048
    buffer_load_dwordx4 v[92:95], v1, s[8:11], s29 offen offset:3072
    s_add_u32 s29, s21, 20480
    buffer_load_dwordx4 v[96:99], v1, s[8:11], s29 offen offset:0
    buffer_load_dwordx4 v[100:103], v1, s[8:11], s29 offen offset:1024
    buffer_load_dwordx4 v[104:107], v1, s[8:11], s29 offen offset:2048
    buffer_load_dwordx4 v[108:111], v1, s[8:11], s29 offen offset:3072
    s_add_u32 s29, s21, 24576
    buffer_load_dwordx4 v[112:115], v1, s[8:11], s29 offen offset:0
    buffer_load_dwordx4 v[116:119], v1, s[8:11], s29 offen offset:1024
    buffer_load_dwordx4 v[120:123], v1, s[8:11], s29 offen offset:2048
    buffer_load_dwordx4 v[124:127], v1, s[8:11], s29 offen offset:3072
    v_add_f32 v128, v128, v130
    v_add_f32 v129, v129, v131
    v_add_f32 v128, v128, v132
    v_add_f32 v129, v129, v133
    v_add_f32 v128, v128, v134
    v_add_f32 v129, v129, v135
    v_add_f32 v128, v128, v136
    v_add_f32 v129, v129, v137
    v_add_f32 v128, v128, v138
    v_add_f32 v129, v129, v139
    v_add_f32 v128, v128, v140
    v_add_f32 v129, v129, v141
    v_mov_b32 v253, v128
    v_mov_b32 v254, v129
    s_nop 1
    v_permlane32_swap_b32 v128, v253
    v_permlane32_swap_b32 v129, v254
    s_nop 1
    v_add_f32 v128, v128, v253
    v_add_f32 v129, v129, v254
    v_mul_f32 v232, 0xbb124925, v128
    v_mul_f32 v253, 0x3b124925, v129
    v_fma_f32 v253, -v232, v232, v253
    v_max_f32 v253, 0, v253
    v_add_f32 v253, 0x3727c5ac, v253
    v_rsq_f32 v233, v253
    s_nop 0
    v_mul_f32 v253, v232, v233
    s_lshl_b32 s20, s3, 8
    s_add_u32 s20, s20, 151552
    v_lshl_add_u32 v254, v2, 2, s20
    v_lshl_add_u32 v255, v3, 4, s20
    ds_write_b32 v254, v233
    ds_write_b32 v254, v253 offset:128
    v_add_u32 v252, 57344, v1
L_qb_mm_45:
    ds_read_b128 v[176:179], v1 offset:28672
    ds_read_b128 v[180:183], v252 offset:0
    ds_read_b128 v[184:187], v1 offset:29696
    ds_read_b128 v[188:191], v252 offset:1024
    s_waitcnt vmcnt(27) lgkmcnt(3)
    v_mfma_f32_32x32x16_bf16 v[144:159], v[176:179], v[16:19], 0
    ds_read_b128 v[176:179], v1 offset:30720
    s_waitcnt lgkmcnt(3)
    v_mfma_f32_32x32x16_bf16 v[160:175], v[16:19], v[180:183], 0
    ds_read_b128 v[180:183], v252 offset:2048
    s_waitcnt vmcnt(26) lgkmcnt(3)
    v_mfma_f32_32x32x16_bf16 v[144:159], v[184:187], v[20:23], v[144:159]
    ds_read_b128 v[184:187], v1 offset:31744
    s_waitcnt lgkmcnt(3)
    v_mfma_f32_32x32x16_bf16 v[160:175], v[20:23], v[188:191], v[160:175]
    ds_read_b128 v[188:191], v252 offset:3072
    s_waitcnt vmcnt(25) lgkmcnt(3)
    v_mfma_f32_32x32x16_bf16 v[144:159], v[176:179], v[24:27], v[144:159]
    ds_read_b128 v[176:179], v1 offset:32768
    s_waitcnt lgkmcnt(3)
    v_mfma_f32_32x32x16_bf16 v[160:175], v[24:27], v[180:183], v[160:175]
    ds_read_b128 v[180:183], v252 offset:4096
    s_waitcnt vmcnt(24) lgkmcnt(3)
    v_mfma_f32_32x32x16_bf16 v[144:159], v[184:187], v[28:31], v[144:159]
    ds_read_b128 v[184:187], v1 offset:33792
    s_waitcnt lgkmcnt(3)
    v_mfma_f32_32x32x16_bf16 v[160:175], v[28:31], v[188:191], v[160:175]
    ds_read_b128 v[188:191], v252 offset:5120
    s_waitcnt vmcnt(23) lgkmcnt(3)
    v_mfma_f32_32x32x16_bf16 v[144:159], v[176:179], v[32:35], v[144:159]
    ds_read_b128 v[176:179], v1 offset:34816
    s_waitcnt lgkmcnt(3)
    v_mfma_f32_32x32x16_bf16 v[160:175], v[32:35], v[180:183], v[160:175]
    ds_read_b128 v[180:183], v252 offset:6144
    s_waitcnt vmcnt(22) lgkmcnt(3)
    v_mfma_f32_32x32x16_bf16 v[144:159], v[184:187], v[36:39], v[144:159]
    ds_read_b128 v[184:187], v1 offset:35840
    s_waitcnt lgkmcnt(3)
    v_mfma_f32_32x32x16_bf16 v[160:175], v[36:39], v[188:191], v[160:175]
    ds_read_b128 v[188:191], v252 offset:7168
    s_waitcnt vmcnt(21) lgkmcnt(3)
    v_mfma_f32_32x32x16_bf16 v[144:159], v[176:179], v[40:43], v[144:159]
    ds_read_b128 v[176:179], v1 offset:36864
    s_waitcnt lgkmcnt(3)
    v_mfma_f32_32x32x16_bf16 v[160:175], v[40:43], v[180:183], v[160:175]
    ds_read_b128 v[180:183], v252 offset:8192
    s_waitcnt vmcnt(20) lgkmcnt(3)
    v_mfma_f32_32x32x16_bf16 v[144:159], v[184:187], v[44:47], v[144:159]
    ds_read_b128 v[184:187], v1 offset:37888
    s_waitcnt lgkmcnt(3)
    v_mfma_f32_32x32x16_bf16 v[160:175], v[44:47], v[188:191], v[160:175]
    ds_read_b128 v[188:191], v252 offset:9216
    s_waitcnt vmcnt(19) lgkmcnt(3)
    v_mfma_f32_32x32x16_bf16 v[144:159], v[176:179], v[48:51], v[144:159]
    ds_read_b128 v[176:179], v1 offset:38912
    s_waitcnt lgkmcnt(3)
    v_mfma_f32_32x32x16_bf16 v[160:175], v[48:51], v[180:183], v[160:175]
    ds_read_b128 v[180:183], v252 offset:10240
    s_waitcnt vmcnt(18) lgkmcnt(3)
    v_mfma_f32_32x32x16_bf16 v[144:159], v[184:187], v[52:55], v[144:159]
    ds_read_b128 v[184:187], v1 offset:39936
    s_waitcnt lgkmcnt(3)
    v_mfma_f32_32x32x16_bf16 v[160:175], v[52:55], v[188:191], v[160:175]
    ds_read_b128 v[188:191], v252 offset:11264
    s_waitcnt vmcnt(17) lgkmcnt(3)
    v_mfma_f32_32x32x16_bf16 v[144:159], v[176:179], v[56:59], v[144:159]
    ds_read_b128 v[176:179], v1 offset:40960
    s_waitcnt lgkmcnt(3)
    v_mfma_f32_32x32x16_bf16 v[160:175], v[56:59], v[180:183], v[160:175]
    ds_read_b128 v[180:183], v252 offset:12288
    s_waitcnt vmcnt(16) lgkmcnt(3)
    v_mfma_f32_32x32x16_bf16 v[144:159], v[184:187], v[60:63], v[144:159]
    ds_read_b128 v[184:187], v1 offset:41984
    s_waitcnt lgkmcnt(3)
    v_mfma_f32_32x32x16_bf16 v[160:175], v[60:63], v[188:191], v[160:175]
    ds_read_b128 v[188:191], v252 offset:13312
    s_waitcnt vmcnt(15) lgkmcnt(3)
    v_mfma_f32_32x32x16_bf16 v[144:159], v[176:179], v[64:67], v[144:159]
    ds_read_b128 v[176:179], v1 offset:43008
    s_waitcnt lgkmcnt(3)
    v_mfma_f32_32x32x16_bf16 v[160:175], v[64:67], v[180:183], v[160:175]
    ds_read_b128 v[180:183], v252 offset:14336
    s_waitcnt vmcnt(14) lgkmcnt(3)
    v_mfma_f32_32x32x16_bf16 v[144:159], v[184:187], v[68:71], v[144:159]
    ds_read_b128 v[184:187], v1 offset:44032
    s_waitcnt lgkmcnt(3)
    v_mfma_f32_32x32x16_bf16 v[160:175], v[68:71], v[188:191], v[160:175]
    ds_read_b128 v[188:191], v252 offset:15360
    s_waitcnt vmcnt(13) lgkmcnt(3)
    v_mfma_f32_32x32x16_bf16 v[144:159], v[176:179], v[72:75], v[144:159]
    ds_read_b128 v[176:179], v1 offset:45056
    s_waitcnt lgkmcnt(3)
    v_mfma_f32_32x32x16_bf16 v[160:175], v[72:75], v[180:183], v[160:175]
    ds_read_b128 v[180:183], v252 offset:16384
    s_waitcnt vmcnt(12) lgkmcnt(3)
    v_mfma_f32_32x32x16_bf16 v[144:159], v[184:187], v[76:79], v[144:159]
    ds_read_b128 v[184:187], v1 offset:46080
    s_waitcnt lgkmcnt(3)
    v_mfma_f32_32x32x16_bf16 v[160:175], v[76:79], v[188:191], v[160:175]
    ds_read_b128 v[188:191], v252 offset:17408
    s_waitcnt vmcnt(11) lgkmcnt(3)
    v_mfma_f32_32x32x16_bf16 v[144:159], v[176:179], v[80:83], v[144:159]
    ds_read_b128 v[176:179], v1 offset:47104
    s_waitcnt lgkmcnt(3)
    v_mfma_f32_32x32x16_bf16 v[160:175], v[80:83], v[180:183], v[160:175]
    ds_read_b128 v[180:183], v252 offset:18432
    s_waitcnt vmcnt(10) lgkmcnt(3)
    v_mfma_f32_32x32x16_bf16 v[144:159], v[184:187], v[84:87], v[144:159]
    ds_read_b128 v[184:187], v1 offset:48128
    s_waitcnt lgkmcnt(3)
    v_mfma_f32_32x32x16_bf16 v[160:175], v[84:87], v[188:191], v[160:175]
    ds_read_b128 v[188:191], v252 offset:19456
    s_waitcnt vmcnt(9) lgkmcnt(3)
    v_mfma_f32_32x32x16_bf16 v[144:159], v[176:179], v[88:91], v[144:159]
    ds_read_b128 v[176:179], v1 offset:49152
    s_waitcnt lgkmcnt(3)
    v_mfma_f32_32x32x16_bf16 v[160:175], v[88:91], v[180:183], v[160:175]
    ds_read_b128 v[180:183], v252 offset:20480
    s_waitcnt vmcnt(8) lgkmcnt(3)
    v_mfma_f32_32x32x16_bf16 v[144:159], v[184:187], v[92:95], v[144:159]
    ds_read_b128 v[184:187], v1 offset:50176
    s_waitcnt lgkmcnt(3)
    v_mfma_f32_32x32x16_bf16 v[160:175], v[92:95], v[188:191], v[160:175]
    ds_read_b128 v[188:191], v252 offset:21504
    s_waitcnt vmcnt(7) lgkmcnt(3)
    v_mfma_f32_32x32x16_bf16 v[144:159], v[176:179], v[96:99], v[144:159]
    ds_read_b128 v[176:179], v1 offset:51200
    s_waitcnt lgkmcnt(3)
    v_mfma_f32_32x32x16_bf16 v[160:175], v[96:99], v[180:183], v[160:175]
    ds_read_b128 v[180:183], v252 offset:22528
    s_waitcnt vmcnt(6) lgkmcnt(3)
    v_mfma_f32_32x32x16_bf16 v[144:159], v[184:187], v[100:103], v[144:159]
    ds_read_b128 v[184:187], v1 offset:52224
    s_waitcnt lgkmcnt(3)
    v_mfma_f32_32x32x16_bf16 v[160:175], v[100:103], v[188:191], v[160:175]
    ds_read_b128 v[188:191], v252 offset:23552
    s_waitcnt vmcnt(5) lgkmcnt(3)
    v_mfma_f32_32x32x16_bf16 v[144:159], v[176:179], v[104:107], v[144:159]
    ds_read_b128 v[176:179], v1 offset:53248
    s_waitcnt lgkmcnt(3)
    v_mfma_f32_32x32x16_bf16 v[160:175], v[104:107], v[180:183], v[160:175]
    ds_read_b128 v[180:183], v252 offset:24576
    s_waitcnt vmcnt(4) lgkmcnt(3)
    v_mfma_f32_32x32x16_bf16 v[144:159], v[184:187], v[108:111], v[144:159]
    ds_read_b128 v[184:187], v1 offset:54272
    s_waitcnt lgkmcnt(3)
    v_mfma_f32_32x32x16_bf16 v[160:175], v[108:111], v[188:191], v[160:175]
    ds_read_b128 v[188:191], v252 offset:25600
    s_waitcnt vmcnt(3) lgkmcnt(3)
    v_mfma_f32_32x32x16_bf16 v[144:159], v[176:179], v[112:115], v[144:159]
    ds_read_b128 v[176:179], v1 offset:55296
    s_waitcnt lgkmcnt(3)
    v_mfma_f32_32x32x16_bf16 v[160:175], v[112:115], v[180:183], v[160:175]
    ds_read_b128 v[180:183], v252 offset:26624
    s_waitcnt vmcnt(2) lgkmcnt(3)
    v_mfma_f32_32x32x16_bf16 v[144:159], v[184:187], v[116:119], v[144:159]
    ds_read_b128 v[184:187], v1 offset:56320
    s_waitcnt lgkmcnt(3)
    v_mfma_f32_32x32x16_bf16 v[160:175], v[116:119], v[188:191], v[160:175]
    ds_read_b128 v[188:191], v252 offset:27648
    s_waitcnt vmcnt(1) lgkmcnt(3)
    v_mfma_f32_32x32x16_bf16 v[144:159], v[176:179], v[120:123], v[144:159]
    s_waitcnt lgkmcnt(2)
    v_mfma_f32_32x32x16_bf16 v[160:175], v[120:123], v[180:183], v[160:175]
    s_waitcnt vmcnt(0) lgkmcnt(1)
    v_mfma_f32_32x32x16_bf16 v[144:159], v[184:187], v[124:127], v[144:159]
    s_waitcnt lgkmcnt(0)
    v_mfma_f32_32x32x16_bf16 v[160:175], v[124:127], v[188:191], v[160:175]
    s_nop 3
    ds_read_b128 v[128:131], v255 offset:0
    ds_read_b128 v[176:179], v255 offset:128
    ds_read_b128 v[132:135], v255 offset:32
    ds_read_b128 v[180:183], v255 offset:160
    ds_read_b128 v[136:139], v255 offset:64
    ds_read_b128 v[184:187], v255 offset:192
    ds_read_b128 v[140:143], v255 offset:96
    ds_read_b128 v[188:191], v255 offset:224
    v_cmp_u_f32 vcc, v144, v144
    v_mul_f32 v253, 0x3e8b97f6, v233
    v_cmp_eq_u32 s[24:25], 28, v2
    s_cmp_lg_u64 vcc, 0
    s_cbranch_scc1 L_qb_redo_46
L_qb_ok_47:
    v_pk_fma_f32 v[144:145], v[232:233], v[208:209], v[144:145] op_sel_hi:[0,1,1]
    v_pk_fma_f32 v[146:147], v[232:233], v[210:211], v[146:147] op_sel_hi:[0,1,1]
    v_pk_fma_f32 v[148:149], v[232:233], v[212:213], v[148:149] op_sel_hi:[0,1,1]
    v_pk_fma_f32 v[150:151], v[232:233], v[214:215], v[150:151] op_sel_hi:[0,1,1]
    v_pk_fma_f32 v[152:153], v[232:233], v[216:217], v[152:153] op_sel_hi:[0,1,1]
    v_pk_fma_f32 v[154:155], v[232:233], v[218:219], v[154:155] op_sel_hi:[0,1,1]
    v_pk_fma_f32 v[156:157], v[232:233], v[220:221], v[156:157] op_sel_hi:[0,1,1]
    v_pk_fma_f32 v[158:159], v[232:233], v[222:223], v[158:159] op_sel_hi:[0,1,1]
    v_pk_mul_f32 v[144:145], v[232:233], v[144:145] op_sel:[1,0] op_sel_hi:[1,1]
    v_pk_mul_f32 v[146:147], v[232:233], v[146:147] op_sel:[1,0] op_sel_hi:[1,1]
    v_pk_mul_f32 v[148:149], v[232:233], v[148:149] op_sel:[1,0] op_sel_hi:[1,1]
    v_pk_mul_f32 v[150:151], v[232:233], v[150:151] op_sel:[1,0] op_sel_hi:[1,1]
    v_pk_mul_f32 v[152:153], v[232:233], v[152:153] op_sel:[1,0] op_sel_hi:[1,1]
    v_pk_mul_f32 v[154:155], v[232:233], v[154:155] op_sel:[1,0] op_sel_hi:[1,1]
    v_pk_mul_f32 v[156:157], v[232:233], v[156:157] op_sel:[1,0] op_sel_hi:[1,1]
    v_pk_mul_f32 v[158:159], v[232:233], v[158:159] op_sel:[1,0] op_sel_hi:[1,1]
    v_cvt_pk_bf16_f32 v144, v144, v145
    v_cvt_pk_bf16_f32 v145, v146, v147
    v_cvt_pk_bf16_f32 v146, v148, v149
    v_cvt_pk_bf16_f32 v147, v150, v151
    v_cvt_pk_bf16_f32 v148, v152, v153
    v_cvt_pk_bf16_f32 v149, v154, v155
    v_cvt_pk_bf16_f32 v150, v156, v157
    v_cvt_pk_bf16_f32 v151, v158, v159
    v_cmp_eq_u32 vcc, 1, v3
    v_mov_b32 v249, 0
    v_mov_b32 v248, 0x3f803f80
    v_mov_b32 v254, 0x00003f80
    v_dot2_f32_bf16 v249, v144, v144, v249
    v_dot2_f32_bf16 v249, v145, v145, v249
    v_dot2_f32_bf16 v249, v146, v146, v249
    v_dot2_f32_bf16 v249, v147, v147, v249
    v_dot2_f32_bf16 v249, v148, v148, v249
    v_dot2_f32_bf16 v249, v149, v149, v249
    v_dot2_f32_bf16 v249, v150, v150, v249
    v_dot2_f32_bf16 v249, v151, v151, v249
    s_lshl_b32 s20, s5, 17
    s_lshl_b32 s21, s6, 11
    s_add_u32 s20, s20, s21
    s_add_u32 s20, s20, s30
    s_add_u32 s21, s20, 8978432
    s_add_u32 s22, s20, 11075584
    s_lshl_b32 s20, s3, 12
    s_add_u32 s20, s20, 118784
    v_cndmask_b32 v150, v150, v248, vcc
    v_cndmask_b32 v151, v151, v254, vcc
    v_add_u32 v254, s20, v1
    v_mov_b32 v250, v249
    v_min_u32 v144, s54, v144
    v_min_u32 v145, s54, v145
    v_min_u32 v146, s54, v146
    v_min_u32 v147, s54, v147
    v_min_u32 v148, s54, v148
    v_min_u32 v149, s54, v149
    v_min_u32 v150, s54, v150
    v_min_u32 v151, s54, v151
    buffer_store_dwordx4 v[144:147], v1, s[8:11], s21 offen sc1
    buffer_store_dwordx4 v[148:151], v1, s[8:11], s21 offen offset:1024 sc1
    v_permlane32_swap_b32 v249, v250
    s_waitcnt lgkmcnt(0)
    v_pk_mul_f32 v[160:161], v[160:161], v[128:129]
    v_pk_mul_f32 v[162:163], v[162:163], v[130:131]
    v_pk_mul_f32 v[164:165], v[164:165], v[132:133]
    v_pk_mul_f32 v[166:167], v[166:167], v[134:135]
    v_pk_mul_f32 v[168:169], v[168:169], v[136:137]
    v_pk_mul_f32 v[170:171], v[170:171], v[138:139]
    v_pk_mul_f32 v[172:173], v[172:173], v[140:141]
    v_pk_mul_f32 v[174:175], v[174:175], v[142:143]
    v_add_f32 v249, v249, v250
    v_pk_fma_f32 v[160:161], v[250:251], v[176:177], v[160:161] op_sel:[1,0,0] op_sel_hi:[1,1,1]
    v_pk_fma_f32 v[162:163], v[250:251], v[178:179], v[162:163] op_sel:[1,0,0] op_sel_hi:[1,1,1]
    v_pk_fma_f32 v[164:165], v[250:251], v[180:181], v[164:165] op_sel:[1,0,0] op_sel_hi:[1,1,1]
    v_pk_fma_f32 v[166:167], v[250:251], v[182:183], v[166:167] op_sel:[1,0,0] op_sel_hi:[1,1,1]
    v_pk_fma_f32 v[168:169], v[250:251], v[184:185], v[168:169] op_sel:[1,0,0] op_sel_hi:[1,1,1]
    v_pk_fma_f32 v[170:171], v[250:251], v[186:187], v[170:171] op_sel:[1,0,0] op_sel_hi:[1,1,1]
    v_pk_fma_f32 v[172:173], v[250:251], v[188:189], v[172:173] op_sel:[1,0,0] op_sel_hi:[1,1,1]
    v_pk_fma_f32 v[174:175], v[250:251], v[190:191], v[174:175] op_sel:[1,0,0] op_sel_hi:[1,1,1]
    v_max_f32_dpp v249, v249, v249 quad_perm:[1,0,3,2] row_mask:0xf bank_mask:0xf
    v_cvt_pk_bf16_f32 v160, v160, v161
    v_cvt_pk_bf16_f32 v161, v162, v163
    v_cvt_pk_bf16_f32 v162, v164, v165
    v_cvt_pk_bf16_f32 v163, v166, v167
    v_cvt_pk_bf16_f32 v164, v168, v169
    v_cvt_pk_bf16_f32 v165, v170, v171
    v_cvt_pk_bf16_f32 v166, v172, v173
    v_cvt_pk_bf16_f32 v167, v174, v175
    v_max_f32_dpp v249, v249, v249 quad_perm:[2,3,0,1] row_mask:0xf bank_mask:0xf
    v_cndmask_b32 v160, v160, v248, s[24:25]
    v_cndmask_b32 v161, v161, v248, s[24:25]
    v_cndmask_b32 v162, v162, v248, s[24:25]
    v_cndmask_b32 v163, v163, v248, s[24:25]
    v_cndmask_b32 v164, v164, v248, s[24:25]
    v_cndmask_b32 v165, v165, v248, s[24:25]
    v_cndmask_b32 v166, v166, v248, s[24:25]
    v_cndmask_b32 v167, v167, v248, s[24:25]
    v_max_f32_dpp v249, v249, v249 row_half_mirror row_mask:0xf bank_mask:0xf
    v_min_u32 v160, s54, v160
    v_min_u32 v161, s54, v161
    v_min_u32 v162, s54, v162
    v_min_u32 v163, s54, v163
    v_min_u32 v164, s54, v164
    v_min_u32 v165, s54, v165
    v_min_u32 v166, s54, v166
    v_min_u32 v167, s54, v167
    v_max_f32_dpp v249, v249, v249 row_mirror row_mask:0xf bank_mask:0xf
    buffer_store_dwordx4 v[160:163], v1, s[8:11], s22 offen sc1
    buffer_store_dwordx4 v[164:167], v1, s[8:11], s22 offen offset:1024 sc1
    s_lshl_b32 s20, s5, 4
    s_add_u32 s20, s20, s4
    s_lshl_b32 s20, s20, 7
    s_lshl_b32 s21, s3, 2
    s_add_u32 s20, s20, s21
    s_add_u32 s20, s20, s30
    s_add_u32 s20, s20, 688128
    v_readlane_b32 s24, v249, 0
    v_readlane_b32 s25, v249, 16
    s_add_u32 s21, s21, 154624
    v_mov_b32 v250, 0
    v_mov_b32 v251, s21
    s_max_u32 s24, s24, s25
    s_min_u32 s24, s24, 0x7fc00000
    v_mov_b32 v248, s24
    s_mov_b64 exec, 1
    buffer_store_dword v248, v250, s[8:11], s20 offen sc1
    ds_write_b32 v251, v248
    s_mov_b64 exec, -1
    ds_write_b128 v254, v[144:147]
    ds_write_b128 v254, v[148:151] offset:1024
    ds_write_b128 v254, v[160:163] offset:2048
    ds_write_b128 v254, v[164:167] offset:3072
    ds_read_b128 v[176:179], v1 offset:0
    ds_read_b128 v[180:183], v1 offset:1024
    ds_read_b128 v[184:187], v1 offset:2048
    ds_read_b128 v[188:191], v1 offset:3072
    s_waitcnt lgkmcnt(3)
    v_mfma_f32_32x32x16_bf16 v[128:143], v[176:179], v[16:19], 0
    ds_read_b128 v[176:179], v1 offset:4096
    s_waitcnt lgkmcnt(3)
    v_mfma_f32_32x32x16_bf16 v[128:143], v[180:183], v[20:23], v[128:143]
    ds_read_b128 v[180:183], v1 offset:5120
    s_waitcnt lgkmcnt(3)
    v_mfma_f32_32x32x16_bf16 v[128:143], v[184:187], v[24:27], v[128:143]
    ds_read_b128 v[184:187], v1 offset:6144
    s_waitcnt lgkmcnt(3)
    v_mfma_f32_32x32x16_bf16 v[128:143], v[188:191], v[28:31], v[128:143]
    ds_read_b128 v[188:191], v1 offset:7168
    s_waitcnt lgkmcnt(3)
    v_mfma_f32_32x32x16_bf16 v[128:143], v[176:179], v[32:35], v[128:143]
    ds_read_b128 v[176:179], v1 offset:8192
    s_waitcnt lgkmcnt(3)
    v_mfma_f32_32x32x16_bf16 v[128:143], v[180:183], v[36:39], v[128:143]
    ds_read_b128 v[180:183], v1 offset:9216
    s_waitcnt lgkmcnt(3)
    v_mfma_f32_32x32x16_bf16 v[128:143], v[184:187], v[40:43], v[128:143]
    ds_read_b128 v[184:187], v1 offset:10240
    s_waitcnt lgkmcnt(3)
    v_mfma_f32_32x32x16_bf16 v[128:143], v[188:191], v[44:47], v[128:143]
    ds_read_b128 v[188:191], v1 offset:11264
    s_waitcnt lgkmcnt(3)
    v_mfma_f32_32x32x16_bf16 v[128:143], v[176:179], v[48:51], v[128:143]
    ds_read_b128 v[176:179], v1 offset:12288
    s_waitcnt lgkmcnt(3)
    v_mfma_f32_32x32x16_bf16 v[128:143], v[180:183], v[52:55], v[128:143]
    ds_read_b128 v[180:183], v1 offset:13312
    s_waitcnt lgkmcnt(3)
    v_mfma_f32_32x32x16_bf16 v[128:143], v[184:187], v[56:59], v[128:143]
    s_waitcnt lgkmcnt(2)
    v_mfma_f32_32x32x16_bf16 v[128:143], v[188:191], v[60:63], v[128:143]
    s_waitcnt lgkmcnt(1)
    v_mfma_f32_32x32x16_bf16 v[128:143], v[176:179], v[64:67], v[128:143]
    s_waitcnt lgkmcnt(0)
    v_mfma_f32_32x32x16_bf16 v[128:143], v[180:183], v[68:71], v[128:143]
    s_lshl_b32 s20, s5, 4
    s_add_u32 s20, s20, s4
    s_lshl_b32 s20, s20, 7
    s_add_u32 s20, s20, s30
    s_add_u32 s21, s20, 687872
    v_lshrrev_b32 v4, 2, v2
    v_and_b32 v4, 1, v4
    v_and_b32 v5, 3, v2
    v_lshlrev_b32 v6, 7, v4
    v_lshl_add_u32 v6, v5, 2, v6
    v_add_u32 v7, s4, v4
    v_cmp_gt_u32 s[26:27], 2, v7
    v_mov_b32 v8, 256
    v_lshl_add_u32 v8, v5, 2, v8
    v_cndmask_b32 v6, v6, v8, s[26:27]
    s_lshl_b32 s24, s4, 2
    s_lshl_b32 s23, s3, 1
    s_add_u32 s24, s24, s23
    s_lshl_b32 s22, s24, 11
    s_lshl_b32 s23, s5, 17
    s_add_u32 s22, s22, s23
    s_add_u32 s22, s22, s30
    s_add_u32 s23, s22, 11059200
    s_add_u32 s22, s22, 8962048
    s_lshl_b32 s20, s3, 13
    s_add_u32 s20, s20, 86016
    s_add_u32 s25, s20, 2048
    s_add_u32 s26, s20, 4096
    s_mov_b32 s35, 0
L_kb_49:
    buffer_load_dword v12, v6, s[8:11], s21 offen sc1
    s_waitcnt vmcnt(0)
    v_cmp_eq_u32 vcc, -1, v12
    s_nop 1
    s_cmp_lg_u64 vcc, 0
    s_cbranch_scc1 L_kb_r_50
L_kb_ok_51:
    s_cmp_lt_u32 s24, 8
    s_cbranch_scc1 L_ab_nn_52
    s_mov_b32 m0, s20
    s_nop 0
    buffer_load_dwordx4 v1, s[8:11], s22 offen lds
    buffer_load_dwordx4 v1, s[8:11], s22 offen offset:1024 lds
    s_mov_b32 m0, s25
    s_nop 0
    buffer_load_dwordx4 v1, s[8:11], s22 offen offset:2048 lds
    buffer_load_dwordx4 v1, s[8:11], s22 offen offset:3072 lds
    buffer_load_dwordx4 v1, s[8:11], s23 offen lds
    buffer_load_dwordx4 v1, s[8:11], s23 offen offset:1024 lds
    s_mov_b32 m0, s26
    s_nop 0
    buffer_load_dwordx4 v1, s[8:11], s23 offen offset:2048 lds
    buffer_load_dwordx4 v1, s[8:11], s23 offen offset:3072 lds
L_ab_nn_52:
    ds_read_b128 v[176:179], v1 offset:14336
    ds_read_b128 v[180:183], v1 offset:15360
    ds_read_b128 v[184:187], v1 offset:16384
    ds_read_b128 v[188:191], v1 offset:17408
    s_waitcnt lgkmcnt(3)
    v_mfma_f32_32x32x16_bf16 v[128:143], v[176:179], v[72:75], v[128:143]
    ds_read_b128 v[176:179], v1 offset:18432
    s_waitcnt lgkmcnt(3)
    v_mfma_f32_32x32x16_bf16 v[128:143], v[180:183], v[76:79], v[128:143]
    ds_read_b128 v[180:183], v1 offset:19456
    s_waitcnt lgkmcnt(3)
    v_mfma_f32_32x32x16_bf16 v[128:143], v[184:187], v[80:83], v[128:143]
    ds_read_b128 v[184:187], v1 offset:20480
    s_waitcnt lgkmcnt(3)
    v_mfma_f32_32x32x16_bf16 v[128:143], v[188:191], v[84:87], v[128:143]
    ds_read_b128 v[188:191], v1 offset:21504
    s_waitcnt lgkmcnt(3)
    v_mfma_f32_32x32x16_bf16 v[128:143], v[176:179], v[88:91], v[128:143]
    ds_read_b128 v[176:179], v1 offset:22528
    s_waitcnt lgkmcnt(3)
    v_mfma_f32_32x32x16_bf16 v[128:143], v[180:183], v[92:95], v[128:143]
    ds_read_b128 v[180:183], v1 offset:23552
    s_waitcnt lgkmcnt(3)
    v_mfma_f32_32x32x16_bf16 v[128:143], v[184:187], v[96:99], v[128:143]
    ds_read_b128 v[184:187], v1 offset:24576
    s_waitcnt lgkmcnt(3)
    v_mfma_f32_32x32x16_bf16 v[128:143], v[188:191], v[100:103], v[128:143]
    ds_read_b128 v[188:191], v1 offset:25600
    s_waitcnt lgkmcnt(3)
    v_mfma_f32_32x32x16_bf16 v[128:143], v[176:179], v[104:107], v[128:143]
    ds_read_b128 v[176:179], v1 offset:26624
    s_waitcnt lgkmcnt(3)
    v_mfma_f32_32x32x16_bf16 v[128:143], v[180:183], v[108:111], v[128:143]
    ds_read_b128 v[180:183], v1 offset:27648
    s_waitcnt lgkmcnt(3)
    v_mfma_f32_32x32x16_bf16 v[128:143], v[184:187], v[112:115], v[128:143]
    s_waitcnt lgkmcnt(2)
    v_mfma_f32_32x32x16_bf16 v[128:143], v[188:191], v[116:119], v[128:143]
    s_waitcnt lgkmcnt(1)
    v_mfma_f32_32x32x16_bf16 v[128:143], v[176:179], v[120:123], v[128:143]
    s_waitcnt lgkmcnt(0)
    v_mfma_f32_32x32x16_bf16 v[128:143], v[180:183], v[124:127], v[128:143]
    v_mov_b32 v248, 0
    s_nop 7
    s_nop 2
    v_pk_fma_f32 v[128:129], v[232:233], v[192:193], v[128:129] op_sel_hi:[0,1,1]
    v_pk_fma_f32 v[130:131], v[232:233], v[194:195], v[130:131] op_sel_hi:[0,1,1]
    v_pk_fma_f32 v[132:133], v[232:233], v[196:197], v[132:133] op_sel_hi:[0,1,1]
    v_pk_fma_f32 v[134:135], v[232:233], v[198:199], v[134:135] op_sel_hi:[0,1,1]
    v_pk_fma_f32 v[136:137], v[232:233], v[200:201], v[136:137] op_sel_hi:[0,1,1]
    v_pk_fma_f32 v[138:139], v[232:233], v[202:203], v[138:139] op_sel_hi:[0,1,1]
    v_pk_fma_f32 v[140:141], v[232:233], v[204:205], v[140:141] op_sel_hi:[0,1,1]
    v_pk_fma_f32 v[142:143], v[232:233], v[206:207], v[142:143] op_sel_hi:[0,1,1]
    v_pk_mul_f32 v[128:129], v[252:253], v[128:129] op_sel:[1,0] op_sel_hi:[1,1]
    v_pk_mul_f32 v[130:131], v[252:253], v[130:131] op_sel:[1,0] op_sel_hi:[1,1]
    v_pk_mul_f32 v[132:133], v[252:253], v[132:133] op_sel:[1,0] op_sel_hi:[1,1]
    v_pk_mul_f32 v[134:135], v[252:253], v[134:135] op_sel:[1,0] op_sel_hi:[1,1]
    v_pk_mul_f32 v[136:137], v[252:253], v[136:137] op_sel:[1,0] op_sel_hi:[1,1]
    v_pk_mul_f32 v[138:139], v[252:253], v[138:139] op_sel:[1,0] op_sel_hi:[1,1]
    v_pk_mul_f32 v[140:141], v[252:253], v[140:141] op_sel:[1,0] op_sel_hi:[1,1]
    v_pk_mul_f32 v[142:143], v[252:253], v[142:143] op_sel:[1,0] op_sel_hi:[1,1]
    v_cvt_pk_bf16_f32 v224, v128, v129
    v_cvt_pk_bf16_f32 v225, v130, v131
    v_cvt_pk_bf16_f32 v226, v132, v133
    v_cvt_pk_bf16_f32 v227, v134, v135
    v_cvt_pk_bf16_f32 v228, v136, v137
    v_cvt_pk_bf16_f32 v229, v138, v139
    v_cvt_pk_bf16_f32 v230, v140, v141
    v_cvt_pk_bf16_f32 v231, v142, v143
    v_dot2_f32_bf16 v248, v224, v224, v248
    v_dot2_f32_bf16 v248, v225, v225, v248
    v_dot2_f32_bf16 v248, v226, v226, v248
    v_dot2_f32_bf16 v248, v227, v227, v248
    v_dot2_f32_bf16 v248, v228, v228, v248
    v_dot2_f32_bf16 v248, v229, v229, v248
    v_dot2_f32_bf16 v248, v230, v230, v248
    v_dot2_f32_bf16 v248, v231, v231, v248
    s_nop 3
    v_mov_b32 v233, v248
    s_nop 1
    v_permlane32_swap_b32 v248, v233
    s_nop 1
    v_add_f32 v232, v248, v233
    v_lshlrev_b32 v9, 2, v3
    v_sub_u32 v9, v2, v9
    v_cvt_f32_i32 v9, v9
    v_add_f32 v9, 0.5, v9
    v_mul_f32 v9, 0x71c9f2ca, v9
    v_subrev_f32 v96, 0x00000000, v9
    v_subrev_f32 v97, 0x71c9f2ca, v9
    v_subrev_f32 v98, 0x7249f2ca, v9
    v_subrev_f32 v99, 0x72977617, v9
    v_subrev_f32 v100, 0x7349f2ca, v9
    v_subrev_f32 v101, 0x73633123, v9
    v_subrev_f32 v102, 0x737c6f7c, v9
    v_subrev_f32 v103, 0x738ad6eb, v9
    v_subrev_f32 v104, 0x73c9f2ca, v9
    v_subrev_f32 v105, 0x73d691f6, v9
    v_subrev_f32 v106, 0x73e33123, v9
    v_subrev_f32 v107, 0x73efd050, v9
    v_subrev_f32 v108, 0x74177617, v9
    v_subrev_f32 v109, 0x741dc5ae, v9
    v_subrev_f32 v110, 0x74241544, v9
    v_subrev_f32 v111, 0x742a64da, v9
    v_min_f32 v80, 0, v96
    v_min_f32_e64 v96, 0, -v96
    v_min_f32 v81, 0, v97
    v_min_f32_e64 v97, 0, -v97
    v_min_f32 v82, 0, v98
    v_min_f32_e64 v98, 0, -v98
    v_min_f32 v83, 0, v99
    v_min_f32_e64 v99, 0, -v99
    v_min_f32 v84, 0, v100
    v_min_f32_e64 v100, 0, -v100
    v_min_f32 v85, 0, v101
    v_min_f32_e64 v101, 0, -v101
    v_min_f32 v86, 0, v102
    v_min_f32_e64 v102, 0, -v102
    v_min_f32 v87, 0, v103
    v_min_f32_e64 v103, 0, -v103
    v_min_f32 v88, 0, v104
    v_min_f32_e64 v104, 0, -v104
    v_min_f32 v89, 0, v105
    v_min_f32_e64 v105, 0, -v105
    v_min_f32 v90, 0, v106
    v_min_f32_e64 v106, 0, -v106
    v_min_f32 v91, 0, v107
    v_min_f32_e64 v107, 0, -v107
    v_min_f32 v92, 0, v108
    v_min_f32_e64 v108, 0, -v108
    v_min_f32 v93, 0, v109
    v_min_f32_e64 v109, 0, -v109
    v_min_f32 v94, 0, v110
    v_min_f32_e64 v110, 0, -v110
    v_min_f32 v95, 0, v111
    v_min_f32_e64 v111, 0, -v111
    s_min_u32 s28, s6, 8
    v_mov_b32 v13, 154624
    s_lshl_b32 s20, s3, 12
    s_add_u32 s20, s20, 118784
    v_add_u32 v11, s20, v1
    s_waitcnt vmcnt(0) lgkmcnt(0)
    s_barrier
    ds_read_b128 v[112:115], v13
    v_subrev_u32 v11, 32768, v11
    s_nop 1
    v_max_f32_dpp v12, v12, v12 quad_perm:[1,0,3,2] row_mask:0xf bank_mask:0xf
    s_nop 1
    v_max_f32_dpp v12, v12, v12 quad_perm:[2,3,0,1] row_mask:0xf bank_mask:0xf
    s_nop 1
    v_max_f32_dpp v12, v12, v12 row_half_mirror row_mask:0xf bank_mask:0xf
    s_nop 1
    v_max_f32_dpp v12, v12, v12 row_mirror row_mask:0xf bank_mask:0xf
    s_waitcnt lgkmcnt(0)
    v_max3_f32 v12, v12, v112, v113
    v_max3_f32 v12, v12, v114, v115
    s_nop 0
    v_readfirstlane_b32 s24, v12
    s_mov_b32 exec_lo, 0
    s_nop 1
    v_mul_f32 v4, s24, v232
    v_sqrt_f32 v4, v4
    s_nop 0
    v_mul_f32 v4, 0x3f828f5c, v4
    v_and_b32 v5, 0xffff0000, v4
    v_sub_f32 v6, v4, v5
    v_and_b32 v7, 0xffff0000, v6
    v_sub_f32 v6, v6, v7
    v_lshrrev_b32 v5, 16, v5
    v_or_b32 v5, v5, v7
    v_lshrrev_b32 v6, 16, v6
    v_xor_b32 v230, 0x80008000, v5
    v_xor_b32 v231, 0x00008000, v6
    s_mov_b64 exec, -1
    s_mov_b32 s29, 0
L_ab_main_53:
    s_lshl_b32 s44, s36, 15
    s_add_u32 s44, s44, 917504
    s_add_u32 s50, s16, s44
    s_addc_u32 s51, s17, 0
    ds_read_b128 v[144:147], v11 offset:32768
    ds_read_b128 v[148:151], v11 offset:33792
    ds_read_b128 v[152:155], v11 offset:34816
    ds_read_b128 v[156:159], v11 offset:35840
    ds_read_b128 v[160:163], v11 offset:28672
    ds_read_b128 v[164:167], v11 offset:29696
    ds_read_b128 v[168:171], v11 offset:30720
    ds_read_b128 v[172:175], v11 offset:31744
    v_mov_b32 v64, 0
    v_mov_b32 v65, 0
    v_mov_b32 v66, 0
    v_mov_b32 v67, 0
    v_mov_b32 v68, 0
    v_mov_b32 v69, 0
    v_mov_b32 v70, 0
    v_mov_b32 v71, 0
    v_mov_b32 v72, 0
    v_mov_b32 v73, 0
    v_mov_b32 v74, 0
    v_mov_b32 v75, 0
    v_mov_b32 v76, 0
    v_mov_b32 v77, 0
    v_mov_b32 v78, 0
    v_mov_b32 v79, 0
    s_waitcnt lgkmcnt(4)
    v_mfma_f32_32x32x16_bf16 v[24:39], v[144:147], v[224:227], v[80:95]
    v_mfma_f32_32x32x16_bf16 v[24:39], v[148:151], v[228:231], v[24:39]
    s_nop 7
    s_nop 3
    v_exp_f32 v24, v24
    v_exp_f32 v25, v25
    v_exp_f32 v26, v26
    v_exp_f32 v27, v27
    s_waitcnt lgkmcnt(0)
    v_mfma_f32_32x32x16_bf16 v[40:55], v[160:163], v[224:227], 0
    v_cvt_pk_bf16_f32 v56, v24, v25
    v_cvt_pk_bf16_f32 v57, v26, v27
    s_add_u32 s48, s50, 0
    s_addc_u32 s49, s51, 0
    global_load_dwordx4 a[112:115], v1, s[48:49] offset:0
    v_exp_f32 v28, v28
    v_exp_f32 v29, v29
    v_exp_f32 v30, v30
    v_exp_f32 v31, v31
    v_mfma_f32_32x32x16_bf16 v[40:55], v[164:167], v[228:231], v[40:55]
    v_cvt_pk_bf16_f32 v58, v28, v29
    v_cvt_pk_bf16_f32 v59, v30, v31
    global_load_dwordx4 a[116:119], v1, s[48:49] offset:1024
    v_exp_f32 v32, v32
    v_exp_f32 v33, v33
    v_exp_f32 v34, v34
    v_exp_f32 v35, v35
    v_cvt_pk_bf16_f32 v60, v32, v33
    v_cvt_pk_bf16_f32 v61, v34, v35
    ds_read_b128 v[176:179], v11 offset:24576
    ds_read_b128 v[180:183], v11 offset:25600
    ds_read_b128 v[184:187], v11 offset:26624
    ds_read_b128 v[188:191], v11 offset:27648
    global_load_dwordx4 a[120:123], v1, s[48:49] offset:2048
    v_exp_f32 v36, v36
    v_exp_f32 v37, v37
    v_exp_f32 v38, v38
    v_exp_f32 v39, v39
    v_mfma_f32_32x32x16_bf16 v[64:79], v[152:155], v[56:59], v[64:79]
    global_load_dwordx4 a[124:127], v1, s[48:49] offset:3072
    v_cvt_pk_bf16_f32 v62, v36, v37
    v_cvt_pk_bf16_f32 v63, v38, v39
    s_cmp_eq_u32 s28, 0
    s_cbranch_scc1 L_ab_x_57
    v_exp_f32 v40, v40
    v_exp_f32 v41, v41
    v_exp_f32 v42, v42
    v_exp_f32 v43, v43
    s_waitcnt lgkmcnt(0)
    v_mfma_f32_32x32x16_bf16 v[24:39], v[176:179], v[224:227], 0
    v_cvt_pk_bf16_f32 v56, v40, v41
    v_cvt_pk_bf16_f32 v57, v42, v43
    s_add_u32 s48, s50, 4096
    s_addc_u32 s49, s51, 0
    global_load_dwordx4 a[128:131], v1, s[48:49] offset:0
    v_exp_f32 v44, v44
    v_exp_f32 v45, v45
    v_exp_f32 v46, v46
    v_exp_f32 v47, v47
    v_mfma_f32_32x32x16_bf16 v[24:39], v[180:183], v[228:231], v[24:39]
    v_cvt_pk_bf16_f32 v58, v44, v45
    v_cvt_pk_bf16_f32 v59, v46, v47
    global_load_dwordx4 a[132:135], v1, s[48:49] offset:1024
    v_exp_f32 v48, v48
    v_exp_f32 v49, v49
    v_exp_f32 v50, v50
    v_exp_f32 v51, v51
    v_mfma_f32_32x32x16_bf16 v[64:79], v[156:159], v[60:63], v[64:79]
    v_cvt_pk_bf16_f32 v60, v48, v49
    v_cvt_pk_bf16_f32 v61, v50, v51
    ds_read_b128 v[144:147], v11 offset:20480
    ds_read_b128 v[148:151], v11 offset:21504
    ds_read_b128 v[152:155], v11 offset:22528
    ds_read_b128 v[156:159], v11 offset:23552
    global_load_dwordx4 a[136:139], v1, s[48:49] offset:2048
    v_exp_f32 v52, v52
    v_exp_f32 v53, v53
    v_exp_f32 v54, v54
    v_exp_f32 v55, v55
    v_mfma_f32_32x32x16_bf16 v[64:79], v[168:171], v[56:59], v[64:79]
    global_load_dwordx4 a[140:143], v1, s[48:49] offset:3072
    v_cvt_pk_bf16_f32 v62, v52, v53
    v_cvt_pk_bf16_f32 v63, v54, v55
    s_cmp_eq_u32 s28, 1
    s_cbranch_scc1 L_ab_x_58
    v_exp_f32 v24, v24
    v_exp_f32 v25, v25
    v_exp_f32 v26, v26
    v_exp_f32 v27, v27
    s_waitcnt lgkmcnt(0)
    v_mfma_f32_32x32x16_bf16 v[40:55], v[144:147], v[224:227], 0
    v_cvt_pk_bf16_f32 v56, v24, v25
    v_cvt_pk_bf16_f32 v57, v26, v27
    s_add_u32 s48, s50, 8192
    s_addc_u32 s49, s51, 0
    global_load_dwordx4 a[144:147], v1, s[48:49] offset:0
    v_exp_f32 v28, v28
    v_exp_f32 v29, v29
    v_exp_f32 v30, v30
    v_exp_f32 v31, v31
    v_mfma_f32_32x32x16_bf16 v[40:55], v[148:151], v[228:231], v[40:55]
    v_cvt_pk_bf16_f32 v58, v28, v29
    v_cvt_pk_bf16_f32 v59, v30, v31
    global_load_dwordx4 a[148:151], v1, s[48:49] offset:1024
    v_exp_f32 v32, v32
    v_exp_f32 v33, v33
    v_exp_f32 v34, v34
    v_exp_f32 v35, v35
    v_mfma_f32_32x32x16_bf16 v[64:79], v[172:175], v[60:63], v[64:79]
    v_cvt_pk_bf16_f32 v60, v32, v33
    v_cvt_pk_bf16_f32 v61, v34, v35
    ds_read_b128 v[160:163], v11 offset:16384
    ds_read_b128 v[164:167], v11 offset:17408
    ds_read_b128 v[168:171], v11 offset:18432
    ds_read_b128 v[172:175], v11 offset:19456
    global_load_dwordx4 a[152:155], v1, s[48:49] offset:2048
    v_exp_f32 v36, v36
    v_exp_f32 v37, v37
    v_exp_f32 v38, v38
    v_exp_f32 v39, v39
    v_mfma_f32_32x32x16_bf16 v[64:79], v[184:187], v[56:59], v[64:79]
    global_load_dwordx4 a[156:159], v1, s[48:49] offset:3072
    v_cvt_pk_bf16_f32 v62, v36, v37
    v_cvt_pk_bf16_f32 v63, v38, v39
    s_cmp_eq_u32 s28, 2
    s_cbranch_scc1 L_ab_x_59
    v_exp_f32 v40, v40
    v_exp_f32 v41, v41
    v_exp_f32 v42, v42
    v_exp_f32 v43, v43
    s_waitcnt lgkmcnt(0)
    v_mfma_f32_32x32x16_bf16 v[24:39], v[160:163], v[224:227], 0
    v_cvt_pk_bf16_f32 v56, v40, v41
    v_cvt_pk_bf16_f32 v57, v42, v43
    s_add_u32 s48, s50, 12288
    s_addc_u32 s49, s51, 0
    global_load_dwordx4 a[160:163], v1, s[48:49] offset:0
    v_exp_f32 v44, v44
    v_exp_f32 v45, v45
    v_exp_f32 v46, v46
    v_exp_f32 v47, v47
    v_mfma_f32_32x32x16_bf16 v[24:39], v[164:167], v[228:231], v[24:39]
    v_cvt_pk_bf16_f32 v58, v44, v45
    v_cvt_pk_bf16_f32 v59, v46, v47
    global_load_dwordx4 a[164:167], v1, s[48:49] offset:1024
    v_exp_f32 v48, v48
    v_exp_f32 v49, v49
    v_exp_f32 v50, v50
    v_exp_f32 v51, v51
    v_mfma_f32_32x32x16_bf16 v[64:79], v[188:191], v[60:63], v[64:79]
    v_cvt_pk_bf16_f32 v60, v48, v49
    v_cvt_pk_bf16_f32 v61, v50, v51
    ds_read_b128 v[176:179], v11 offset:12288
    ds_read_b128 v[180:183], v11 offset:13312
    ds_read_b128 v[184:187], v11 offset:14336
    ds_read_b128 v[188:191], v11 offset:15360
    global_load_dwordx4 a[168:171], v1, s[48:49] offset:2048
    v_exp_f32 v52, v52
    v_exp_f32 v53, v53
    v_exp_f32 v54, v54
    v_exp_f32 v55, v55
    v_mfma_f32_32x32x16_bf16 v[64:79], v[152:155], v[56:59], v[64:79]
    global_load_dwordx4 a[172:175], v1, s[48:49] offset:3072
    v_cvt_pk_bf16_f32 v62, v52, v53
    v_cvt_pk_bf16_f32 v63, v54, v55
    s_cmp_eq_u32 s28, 3
    s_cbranch_scc1 L_ab_x_60
    v_exp_f32 v24, v24
    v_exp_f32 v25, v25
    v_exp_f32 v26, v26
    v_exp_f32 v27, v27
    s_waitcnt lgkmcnt(0)
    v_mfma_f32_32x32x16_bf16 v[40:55], v[176:179], v[224:227], 0
    v_cvt_pk_bf16_f32 v56, v24, v25
    v_cvt_pk_bf16_f32 v57, v26, v27
    s_add_u32 s48, s50, 16384
    s_addc_u32 s49, s51, 0
    global_load_dwordx4 a[176:179], v1, s[48:49] offset:0
    v_exp_f32 v28, v28
    v_exp_f32 v29, v29
    v_exp_f32 v30, v30
    v_exp_f32 v31, v31
    v_mfma_f32_32x32x16_bf16 v[40:55], v[180:183], v[228:231], v[40:55]
    v_cvt_pk_bf16_f32 v58, v28, v29
    v_cvt_pk_bf16_f32 v59, v30, v31
    global_load_dwordx4 a[180:183], v1, s[48:49] offset:1024
    v_exp_f32 v32, v32
    v_exp_f32 v33, v33
    v_exp_f32 v34, v34
    v_exp_f32 v35, v35
    v_mfma_f32_32x32x16_bf16 v[64:79], v[156:159], v[60:63], v[64:79]
    v_cvt_pk_bf16_f32 v60, v32, v33
    v_cvt_pk_bf16_f32 v61, v34, v35
    ds_read_b128 v[144:147], v11 offset:8192
    ds_read_b128 v[148:151], v11 offset:9216
    ds_read_b128 v[152:155], v11 offset:10240
    ds_read_b128 v[156:159], v11 offset:11264
    global_load_dwordx4 a[184:187], v1, s[48:49] offset:2048
    v_exp_f32 v36, v36
    v_exp_f32 v37, v37
    v_exp_f32 v38, v38
    v_exp_f32 v39, v39
    v_mfma_f32_32x32x16_bf16 v[64:79], v[168:171], v[56:59], v[64:79]
    global_load_dwordx4 a[188:191], v1, s[48:49] offset:3072
    v_cvt_pk_bf16_f32 v62, v36, v37
    v_cvt_pk_bf16_f32 v63, v38, v39
    s_cmp_eq_u32 s28, 4
    s_cbranch_scc1 L_ab_x_61
    v_exp_f32 v40, v40
    v_exp_f32 v41, v41
    v_exp_f32 v42, v42
    v_exp_f32 v43, v43
    s_waitcnt lgkmcnt(0)
    v_mfma_f32_32x32x16_bf16 v[24:39], v[144:147], v[224:227], 0
    v_cvt_pk_bf16_f32 v56, v40, v41
    v_cvt_pk_bf16_f32 v57, v42, v43
    s_add_u32 s48, s50, 20480
    s_addc_u32 s49, s51, 0
    global_load_dwordx4 a[192:195], v1, s[48:49] offset:0
    v_exp_f32 v44, v44
    v_exp_f32 v45, v45
    v_exp_f32 v46, v46
    v_exp_f32 v47, v47
    v_mfma_f32_32x32x16_bf16 v[24:39], v[148:151], v[228:231], v[24:39]
    v_cvt_pk_bf16_f32 v58, v44, v45
    v_cvt_pk_bf16_f32 v59, v46, v47
    global_load_dwordx4 a[196:199], v1, s[48:49] offset:1024
    v_exp_f32 v48, v48
    v_exp_f32 v49, v49
    v_exp_f32 v50, v50
    v_exp_f32 v51, v51
    v_mfma_f32_32x32x16_bf16 v[64:79], v[172:175], v[60:63], v[64:79]
    v_cvt_pk_bf16_f32 v60, v48, v49
    v_cvt_pk_bf16_f32 v61, v50, v51
    ds_read_b128 v[160:163], v11 offset:4096
    ds_read_b128 v[164:167], v11 offset:5120
    ds_read_b128 v[168:171], v11 offset:6144
    ds_read_b128 v[172:175], v11 offset:7168
    global_load_dwordx4 a[200:203], v1, s[48:49] offset:2048
    v_exp_f32 v52, v52
    v_exp_f32 v53, v53
    v_exp_f32 v54, v54
    v_exp_f32 v55, v55
    v_mfma_f32_32x32x16_bf16 v[64:79], v[184:187], v[56:59], v[64:79]
    global_load_dwordx4 a[204:207], v1, s[48:49] offset:3072
    v_cvt_pk_bf16_f32 v62, v52, v53
    v_cvt_pk_bf16_f32 v63, v54, v55
    s_cmp_eq_u32 s28, 5
    s_cbranch_scc1 L_ab_x_62
    v_exp_f32 v24, v24
    v_exp_f32 v25, v25
    v_exp_f32 v26, v26
    v_exp_f32 v27, v27
    s_waitcnt lgkmcnt(0)
    v_mfma_f32_32x32x16_bf16 v[40:55], v[160:163], v[224:227], 0
    v_cvt_pk_bf16_f32 v56, v24, v25
    v_cvt_pk_bf16_f32 v57, v26, v27
    s_add_u32 s48, s50, 24576
    s_addc_u32 s49, s51, 0
    global_load_dwordx4 a[208:211], v1, s[48:49] offset:0
    v_exp_f32 v28, v28
    v_exp_f32 v29, v29
    v_exp_f32 v30, v30
    v_exp_f32 v31, v31
    v_mfma_f32_32x32x16_bf16 v[40:55], v[164:167], v[228:231], v[40:55]
    v_cvt_pk_bf16_f32 v58, v28, v29
    v_cvt_pk_bf16_f32 v59, v30, v31
    global_load_dwordx4 a[212:215], v1, s[48:49] offset:1024
    v_exp_f32 v32, v32
    v_exp_f32 v33, v33
    v_exp_f32 v34, v34
    v_exp_f32 v35, v35
    v_mfma_f32_32x32x16_bf16 v[64:79], v[188:191], v[60:63], v[64:79]
    v_cvt_pk_bf16_f32 v60, v32, v33
    v_cvt_pk_bf16_f32 v61, v34, v35
    ds_read_b128 v[176:179], v11 offset:0
    ds_read_b128 v[180:183], v11 offset:1024
    ds_read_b128 v[184:187], v11 offset:2048
    ds_read_b128 v[188:191], v11 offset:3072
    global_load_dwordx4 a[216:219], v1, s[48:49] offset:2048
    v_exp_f32 v36, v36
    v_exp_f32 v37, v37
    v_exp_f32 v38, v38
    v_exp_f32 v39, v39
    v_mfma_f32_32x32x16_bf16 v[64:79], v[152:155], v[56:59], v[64:79]
    global_load_dwordx4 a[220:223], v1, s[48:49] offset:3072
    v_cvt_pk_bf16_f32 v62, v36, v37
    v_cvt_pk_bf16_f32 v63, v38, v39
    s_cmp_eq_u32 s28, 6
    s_cbranch_scc1 L_ab_x_63
    v_exp_f32 v40, v40
    v_exp_f32 v41, v41
    v_exp_f32 v42, v42
    v_exp_f32 v43, v43
    s_waitcnt lgkmcnt(0)
    v_mfma_f32_32x32x16_bf16 v[24:39], v[176:179], v[224:227], v[96:111]
    v_cvt_pk_bf16_f32 v56, v40, v41
    v_cvt_pk_bf16_f32 v57, v42, v43
    s_add_u32 s48, s50, 28672
    s_addc_u32 s49, s51, 0
    global_load_dwordx4 a[224:227], v1, s[48:49] offset:0
    v_exp_f32 v44, v44
    v_exp_f32 v45, v45
    v_exp_f32 v46, v46
    v_exp_f32 v47, v47
    v_mfma_f32_32x32x16_bf16 v[24:39], v[180:183], v[228:231], v[24:39]
    v_cvt_pk_bf16_f32 v58, v44, v45
    v_cvt_pk_bf16_f32 v59, v46, v47
    global_load_dwordx4 a[228:231], v1, s[48:49] offset:1024
    v_exp_f32 v48, v48
    v_exp_f32 v49, v49
    v_exp_f32 v50, v50
    v_exp_f32 v51, v51
    v_mfma_f32_32x32x16_bf16 v[64:79], v[156:159], v[60:63], v[64:79]
    v_cvt_pk_bf16_f32 v60, v48, v49
    v_cvt_pk_bf16_f32 v61, v50, v51
    global_load_dwordx4 a[232:235], v1, s[48:49] offset:2048
    v_exp_f32 v52, v52
    v_exp_f32 v53, v53
    v_exp_f32 v54, v54
    v_exp_f32 v55, v55
    v_mfma_f32_32x32x16_bf16 v[64:79], v[168:171], v[56:59], v[64:79]
    global_load_dwordx4 a[236:239], v1, s[48:49] offset:3072
    v_cvt_pk_bf16_f32 v62, v52, v53
    v_cvt_pk_bf16_f32 v63, v54, v55
    s_cmp_eq_u32 s28, 7
    s_cbranch_scc1 L_ab_x_64
    v_exp_f32 v24, v24
    v_exp_f32 v25, v25
    v_exp_f32 v26, v26
    v_exp_f32 v27, v27
    v_cvt_pk_bf16_f32 v56, v24, v25
    v_cvt_pk_bf16_f32 v57, v26, v27
    v_exp_f32 v28, v28
    v_exp_f32 v29, v29
    v_exp_f32 v30, v30
    v_exp_f32 v31, v31
    v_cvt_pk_bf16_f32 v58, v28, v29
    v_cvt_pk_bf16_f32 v59, v30, v31
    v_exp_f32 v32, v32
    v_exp_f32 v33, v33
    v_exp_f32 v34, v34
    v_exp_f32 v35, v35
    v_mfma_f32_32x32x16_bf16 v[64:79], v[172:175], v[60:63], v[64:79]
    v_cvt_pk_bf16_f32 v60, v32, v33
    v_cvt_pk_bf16_f32 v61, v34, v35
    v_exp_f32 v36, v36
    v_exp_f32 v37, v37
    v_exp_f32 v38, v38
    v_exp_f32 v39, v39
    v_mfma_f32_32x32x16_bf16 v[64:79], v[184:187], v[56:59], v[64:79]
    v_cvt_pk_bf16_f32 v62, v36, v37
    v_cvt_pk_bf16_f32 v63, v38, v39
    s_nop 1
    v_mfma_f32_32x32x16_bf16 v[64:79], v[188:191], v[60:63], v[64:79]
L_ab_fin_54:
    s_lshl_b32 s20, s6, 15
    s_lshl_b32 s21, s5, 11
    s_add_u32 s20, s20, s21
    s_add_u32 s20, s20, s30
    s_add_u32 s20, s20, 13172736
    s_lshl_b32 s21, s6, 11
    s_lshl_b32 s22, s5, 7
    s_add_u32 s21, s21, s22
    s_add_u32 s21, s21, s30
    s_add_u32 s21, s21, 557056
    s_mov_b32 s22, 0x17800000
    v_mov_b32 v8, 0
    s_waitcnt lgkmcnt(0)
    v_mov_b32 v6, v76
    v_mov_b32 v7, v76
    v_pk_add_f32 v[24:25], v[64:65], v[66:67]
    v_pk_add_f32 v[26:27], v[68:69], v[70:71]
    v_permlane32_swap_b32 v6, v7
    v_pk_add_f32 v[24:25], v[24:25], v[72:73]
    v_pk_add_f32 v[26:27], v[26:27], v[74:75]
    v_pk_add_f32 v[24:25], v[24:25], v[76:77]
    v_pk_add_f32 v[26:27], v[26:27], v[78:79]
    v_pk_add_f32 v[24:25], v[24:25], v[26:27]
    v_cmp_gt_f32 vcc, s22, v7
    v_cmp_u_f32 s[24:25], v24, v25
    v_rcp_f32 v7, v7
    s_or_b64 s[26:27], vcc, s[24:25]
    s_cmp_lg_u64 s[26:27], 0
    s_cbranch_scc1 L_ab_slow_55
L_ab_norm_56:
    v_pk_mul_f32 v[64:65], v[6:7], v[64:65] op_sel:[1,0] op_sel_hi:[1,1]
    v_pk_mul_f32 v[66:67], v[6:7], v[66:67] op_sel:[1,0] op_sel_hi:[1,1]
    v_pk_mul_f32 v[68:69], v[6:7], v[68:69] op_sel:[1,0] op_sel_hi:[1,1]
    v_pk_mul_f32 v[70:71], v[6:7], v[70:71] op_sel:[1,0] op_sel_hi:[1,1]
    v_pk_mul_f32 v[72:73], v[6:7], v[72:73] op_sel:[1,0] op_sel_hi:[1,1]
    v_pk_mul_f32 v[74:75], v[6:7], v[74:75] op_sel:[1,0] op_sel_hi:[1,1]
    v_pk_mul_f32 v[76:77], v[6:7], v[76:77] op_sel:[1,0] op_sel_hi:[1,1]
    v_pk_mul_f32 v[78:79], v[6:7], v[78:79] op_sel:[1,0] op_sel_hi:[1,1]
    v_cvt_pk_bf16_f32 v56, v64, v65
    v_cvt_pk_bf16_f32 v57, v66, v67
    v_cvt_pk_bf16_f32 v58, v68, v69
    v_cvt_pk_bf16_f32 v59, v70, v71
    v_cvt_pk_bf16_f32 v60, v72, v73
    v_cvt_pk_bf16_f32 v61, v74, v75
    v_cvt_pk_bf16_f32 v62, v76, v77
    v_cvt_pk_bf16_f32 v63, v78, v79
    v_min_u32 v56, s54, v56
    v_min_u32 v57, s54, v57
    v_min_u32 v58, s54, v58
    v_min_u32 v59, s54, v59
    v_min_u32 v60, s54, v60
    v_min_u32 v61, s54, v61
    v_min_u32 v62, s54, v62
    v_min_u32 v63, s54, v63
    buffer_store_dwordx4 v[56:59], v1, s[8:11], s20 offen sc1
    buffer_store_dwordx4 v[60:63], v1, s[8:11], s20 offen offset:1024 sc1
    s_mov_b64 exec, 1
    buffer_store_dword v8, v8, s[8:11], s21 offen sc1
    s_mov_b64 exec, -1
    s_barrier
    s_lshl_b32 s21, s31, 11
    s_add_u32 s21, s21, s30
    s_add_u32 s21, s21, 557056
    v_and_b32 v177, 15, v2
    v_lshlrev_b32 v177, 7, v177
    s_lshl_b32 s20, s31, 15
    s_lshl_b32 s22, s3, 13
    s_add_u32 s20, s20, s22
    s_add_u32 s20, s20, s30
    s_add_u32 s20, s20, 13172736
    s_mov_b32 s27, s20
    s_add_u32 s22, s22, 86016
    v_add_u32 v176, s22, v1
    v_add_u32 v179, 86016, v1
    s_mov_b32 s35, 0
L_ho_108:
    buffer_load_dword v178, v177, s[8:11], s21 offen sc1
    s_waitcnt vmcnt(0)
    v_cmp_eq_u32 vcc, -1, v178
    s_nop 1
    s_cmp_lg_u64 vcc, 0
    s_cbranch_scc1 L_ho_r_109
L_ho_ok_110:
    s_mov_b32 m0, s22
    s_nop 0
    buffer_load_dwordx4 v1, s[8:11], s20 offen offset:0 lds
    buffer_load_dwordx4 v1, s[8:11], s20 offen offset:1024 lds
    buffer_load_dwordx4 v1, s[8:11], s20 offen offset:2048 lds
    buffer_load_dwordx4 v1, s[8:11], s20 offen offset:3072 lds
    s_add_u32 s29, s20, 4096
    s_add_u32 s25, s22, 4096
    s_mov_b32 m0, s25
    s_nop 0
    buffer_load_dwordx4 v1, s[8:11], s29 offen offset:0 lds
    buffer_load_dwordx4 v1, s[8:11], s29 offen offset:1024 lds
    buffer_load_dwordx4 v1, s[8:11], s29 offen offset:2048 lds
    buffer_load_dwordx4 v1, s[8:11], s29 offen offset:3072 lds
    v_lshlrev_b32 v160, 16, v240
    v_and_b32 v161, 0xffff0000, v240
    v_lshlrev_b32 v162, 16, v241
    v_and_b32 v163, 0xffff0000, v241
    v_lshlrev_b32 v164, 16, v242
    v_and_b32 v165, 0xffff0000, v242
    v_lshlrev_b32 v166, 16, v243
    v_and_b32 v167, 0xffff0000, v243
    v_lshlrev_b32 v168, 16, v244
    v_and_b32 v169, 0xffff0000, v244
    v_lshlrev_b32 v170, 16, v245
    v_and_b32 v171, 0xffff0000, v245
    v_lshlrev_b32 v172, 16, v246
    v_and_b32 v173, 0xffff0000, v246
    v_lshlrev_b32 v174, 16, v247
    v_and_b32 v175, 0xffff0000, v247
    s_mov_b32 s53, 0
    s_waitcnt vmcnt(0)
    s_barrier
L_op_mm_112:
    ds_read_b128 v[16:19], v179 offset:0
    ds_read_b128 v[20:23], v179 offset:1024
    ds_read_b128 v[24:27], v179 offset:2048
    ds_read_b128 v[28:31], v179 offset:3072
    ds_read_b128 v[32:35], v179 offset:4096
    ds_read_b128 v[36:39], v179 offset:5120
    ds_read_b128 v[40:43], v179 offset:6144
    ds_read_b128 v[44:47], v179 offset:7168
    ds_read_b128 v[48:51], v179 offset:8192
    ds_read_b128 v[52:55], v179 offset:9216
    ds_read_b128 v[56:59], v179 offset:10240
    ds_read_b128 v[60:63], v179 offset:11264
    ds_read_b128 v[64:67], v179 offset:12288
    ds_read_b128 v[68:71], v179 offset:13312
    ds_read_b128 v[72:75], v179 offset:14336
    ds_read_b128 v[76:79], v179 offset:15360
    ds_read_b128 v[80:83], v179 offset:16384
    ds_read_b128 v[84:87], v179 offset:17408
    ds_read_b128 v[88:91], v179 offset:18432
    ds_read_b128 v[92:95], v179 offset:19456
    ds_read_b128 v[96:99], v179 offset:20480
    ds_read_b128 v[100:103], v179 offset:21504
    ds_read_b128 v[104:107], v179 offset:22528
    ds_read_b128 v[108:111], v179 offset:23552
    ds_read_b128 v[112:115], v179 offset:24576
    ds_read_b128 v[116:119], v179 offset:25600
    ds_read_b128 v[120:123], v179 offset:26624
    ds_read_b128 v[124:127], v179 offset:27648
    ds_read_b128 v[128:131], v179 offset:28672
    ds_read_b128 v[132:135], v179 offset:29696
    ds_read_b128 v[136:139], v179 offset:30720
    ds_read_b128 v[140:143], v179 offset:31744
    s_waitcnt lgkmcnt(15)
    v_mfma_f32_32x32x16_bf16 v[144:159], a[112:115], v[16:19], v[160:175]
    s_waitcnt lgkmcnt(15)
    v_mfma_f32_32x32x16_bf16 v[144:159], a[116:119], v[20:23], v[144:159]
    s_waitcnt lgkmcnt(15)
    v_mfma_f32_32x32x16_bf16 v[144:159], a[120:123], v[24:27], v[144:159]
    s_waitcnt lgkmcnt(15)
    v_mfma_f32_32x32x16_bf16 v[144:159], a[124:127], v[28:31], v[144:159]
    s_waitcnt lgkmcnt(15)
    v_mfma_f32_32x32x16_bf16 v[144:159], a[128:131], v[32:35], v[144:159]
    s_waitcnt lgkmcnt(15)
    v_mfma_f32_32x32x16_bf16 v[144:159], a[132:135], v[36:39], v[144:159]
    s_waitcnt lgkmcnt(15)
    v_mfma_f32_32x32x16_bf16 v[144:159], a[136:139], v[40:43], v[144:159]
    s_waitcnt lgkmcnt(15)
    v_mfma_f32_32x32x16_bf16 v[144:159], a[140:143], v[44:47], v[144:159]
    s_waitcnt lgkmcnt(15)
    v_mfma_f32_32x32x16_bf16 v[144:159], a[144:147], v[48:51], v[144:159]
    s_waitcnt lgkmcnt(15)
    v_mfma_f32_32x32x16_bf16 v[144:159], a[148:151], v[52:55], v[144:159]
    s_waitcnt lgkmcnt(15)
    v_mfma_f32_32x32x16_bf16 v[144:159], a[152:155], v[56:59], v[144:159]
    s_waitcnt lgkmcnt(15)
    v_mfma_f32_32x32x16_bf16 v[144:159], a[156:159], v[60:63], v[144:159]
    s_waitcnt lgkmcnt(15)
    v_mfma_f32_32x32x16_bf16 v[144:159], a[160:163], v[64:67], v[144:159]
    s_waitcnt lgkmcnt(15)
    v_mfma_f32_32x32x16_bf16 v[144:159], a[164:167], v[68:71], v[144:159]
    s_waitcnt lgkmcnt(15)
    v_mfma_f32_32x32x16_bf16 v[144:159], a[168:171], v[72:75], v[144:159]
    s_waitcnt lgkmcnt(15)
    v_mfma_f32_32x32x16_bf16 v[144:159], a[172:175], v[76:79], v[144:159]
    s_waitcnt lgkmcnt(15)
    v_mfma_f32_32x32x16_bf16 v[144:159], a[176:179], v[80:83], v[144:159]
    s_waitcnt lgkmcnt(14)
    v_mfma_f32_32x32x16_bf16 v[144:159], a[180:183], v[84:87], v[144:159]
    s_waitcnt lgkmcnt(13)
    v_mfma_f32_32x32x16_bf16 v[144:159], a[184:187], v[88:91], v[144:159]
    s_waitcnt lgkmcnt(12)
    v_mfma_f32_32x32x16_bf16 v[144:159], a[188:191], v[92:95], v[144:159]
    s_waitcnt lgkmcnt(11)
    v_mfma_f32_32x32x16_bf16 v[144:159], a[192:195], v[96:99], v[144:159]
    s_waitcnt lgkmcnt(10)
    v_mfma_f32_32x32x16_bf16 v[144:159], a[196:199], v[100:103], v[144:159]
    s_waitcnt lgkmcnt(9)
    v_mfma_f32_32x32x16_bf16 v[144:159], a[200:203], v[104:107], v[144:159]
    s_waitcnt lgkmcnt(8)
    v_mfma_f32_32x32x16_bf16 v[144:159], a[204:207], v[108:111], v[144:159]
    s_waitcnt lgkmcnt(7)
    v_mfma_f32_32x32x16_bf16 v[144:159], a[208:211], v[112:115], v[144:159]
    s_waitcnt lgkmcnt(6)
    v_mfma_f32_32x32x16_bf16 v[144:159], a[212:215], v[116:119], v[144:159]
    s_waitcnt lgkmcnt(5)
    v_mfma_f32_32x32x16_bf16 v[144:159], a[216:219], v[120:123], v[144:159]
    s_waitcnt lgkmcnt(4)
    v_mfma_f32_32x32x16_bf16 v[144:159], a[220:223], v[124:127], v[144:159]
    s_waitcnt lgkmcnt(3)
    v_mfma_f32_32x32x16_bf16 v[144:159], a[224:227], v[128:131], v[144:159]
    s_waitcnt lgkmcnt(2)
    v_mfma_f32_32x32x16_bf16 v[144:159], a[228:231], v[132:135], v[144:159]
    s_waitcnt lgkmcnt(1)
    v_mfma_f32_32x32x16_bf16 v[144:159], a[232:235], v[136:139], v[144:159]
    s_waitcnt lgkmcnt(0)
    v_mfma_f32_32x32x16_bf16 v[144:159], a[236:239], v[140:143], v[144:159]
    s_mul_i32 s20, s31, 28672
    s_lshl_b32 s21, s32, 11
    s_add_u32 s20, s20, s21
    s_add_u32 s20, s20, s30
    s_add_u32 s20, s20, 18481152
    s_lshl_b32 s21, s31, 12
    s_lshl_b32 s22, s32, 8
    s_add_u32 s21, s21, s22
    s_add_u32 s21, s21, s30
    s_add_u32 s21, s21, 15269888
    s_mov_b32 s22, 0x3f803f80
    v_lshlrev_b32 v182, 3, v2
    s_nop 1
    v_cmp_u_f32 vcc, v144, v144
    s_nop 1
    s_cmp_lg_u64 vcc, 0
    s_cbranch_scc1 L_op_redo_113
L_op_ok_114:
    s_cmp_ge_u32 s32, 14
    s_cbranch_scc1 L_op_skip_111
    v_mov_b32 v176, 0
    v_mov_b32 v177, 0
    v_cvt_pk_bf16_f32 v240, v144, v145
    v_cvt_pk_bf16_f32 v241, v146, v147
    v_cvt_pk_bf16_f32 v242, v148, v149
    v_cvt_pk_bf16_f32 v243, v150, v151
    v_cvt_pk_bf16_f32 v244, v152, v153
    v_cvt_pk_bf16_f32 v245, v154, v155
    v_cvt_pk_bf16_f32 v246, v156, v157
    v_cvt_pk_bf16_f32 v247, v158, v159
    s_cmp_lg_u32 s33, 0
    s_cbranch_scc1 L_op_fin_118
    v_min_u32 v240, s54, v240
    v_min_u32 v241, s54, v241
    v_min_u32 v242, s54, v242
    v_min_u32 v243, s54, v243
    v_min_u32 v244, s54, v244
    v_min_u32 v245, s54, v245
    v_min_u32 v246, s54, v246
    v_min_u32 v247, s54, v247
    buffer_store_dwordx4 v[240:243], v1, s[8:11], s20 offen sc1
    buffer_store_dwordx4 v[244:247], v1, s[8:11], s20 offen offset:1024 sc1
    v_dot2_f32_bf16 v176, v240, s22, v176
    v_dot2_f32_bf16 v177, v240, v240, v177
    v_dot2_f32_bf16 v176, v241, s22, v176
    v_dot2_f32_bf16 v177, v241, v241, v177
    v_dot2_f32_bf16 v176, v242, s22, v176
    v_dot2_f32_bf16 v177, v242, v242, v177
    v_dot2_f32_bf16 v176, v243, s22, v176
    v_dot2_f32_bf16 v177, v243, v243, v177
    v_dot2_f32_bf16 v176, v244, s22, v176
    v_dot2_f32_bf16 v177, v244, v244, v177
    v_dot2_f32_bf16 v176, v245, s22, v176
    v_dot2_f32_bf16 v177, v245, v245, v177
    v_dot2_f32_bf16 v176, v246, s22, v176
    v_dot2_f32_bf16 v177, v246, v246, v177
    v_dot2_f32_bf16 v176, v247, s22, v176
    v_dot2_f32_bf16 v177, v247, v247, v177
    s_nop 3
    v_mov_b32 v178, v176
    v_mov_b32 v179, v177
    s_nop 1
    v_permlane32_swap_b32 v176, v178
    v_permlane32_swap_b32 v177, v179
    s_nop 1
    v_add_f32 v176, v176, v178
    v_add_f32 v177, v177, v179
    v_min_u32 v176, s54, v176
    v_min_u32 v177, s54, v177
    s_mov_b32 exec_hi, 0
    buffer_store_dwordx2 v[176:177], v182, s[8:11], s21 offen sc1
    s_mov_b64 exec, -1
L_op_skip_111:
    s_cmp_lg_u32 s33, 0
    s_cbranch_scc1 M_done
    s_mov_b32 s33, 1
    s_add_u32 s30, s30, 15269888
    s_branch M_pair
L_st_r_2:
    s_add_u32 s35, s35, 1
    s_cmp_ge_u32 s35, 65536
    s_cbranch_scc1 L_st_ok_3
    s_sleep 1
    s_branch L_st_1
L_xar_r_8:
    s_add_u32 s35, s35, 1
    s_cmp_ge_u32 s35, 65536
    s_cbranch_scc1 L_xar_ok_9
    s_sleep 1
    s_branch L_xar_7
L_qa_redo_5:
    s_cmp_lg_u32 s53, 0
    s_cbranch_scc1 L_qa_ok_6
    s_mov_b32 s53, 1
    s_barrier
    s_mov_b32 s35, 0
L_xar_7:
    buffer_load_dwordx4 v[16:19], v1, s[8:11], s27 offen offset:0 sc1
    buffer_load_dwordx4 v[20:23], v1, s[8:11], s27 offen offset:1024 sc1
    buffer_load_dwordx4 v[24:27], v1, s[8:11], s27 offen offset:2048 sc1
    buffer_load_dwordx4 v[28:31], v1, s[8:11], s27 offen offset:3072 sc1
    s_add_u32 s29, s27, 4096
    buffer_load_dwordx4 v[32:35], v1, s[8:11], s29 offen offset:0 sc1
    buffer_load_dwordx4 v[36:39], v1, s[8:11], s29 offen offset:1024 sc1
    buffer_load_dwordx4 v[40:43], v1, s[8:11], s29 offen offset:2048 sc1
    s_waitcnt vmcnt(0)
    v_max3_u32 v180, v16, v17, v18
    v_max3_u32 v180, v180, v19, v20
    v_max3_u32 v180, v180, v21, v22
    v_max3_u32 v180, v180, v23, v24
    v_max3_u32 v180, v180, v25, v26
    v_max3_u32 v180, v180, v27, v28
    v_max3_u32 v180, v180, v29, v30
    v_max3_u32 v180, v180, v31, v32
    v_max3_u32 v180, v180, v33, v34
    v_max3_u32 v180, v180, v35, v36
    v_max3_u32 v180, v180, v37, v38
    v_max3_u32 v180, v180, v39, v40
    v_max3_u32 v180, v180, v41, v42
    v_max_u32 v180, v180, v43
    v_cmp_eq_u32 vcc, -1, v180
    s_nop 1
    s_cmp_lg_u64 vcc, 0
    s_cbranch_scc1 L_xar_r_8
L_xar_ok_9:
    ds_write_b128 v181, v[16:19] offset:0
    ds_write_b128 v181, v[20:23] offset:1024
    ds_write_b128 v181, v[24:27] offset:2048
    ds_write_b128 v181, v[28:31] offset:3072
    ds_write_b128 v181, v[32:35] offset:4096
    ds_write_b128 v181, v[36:39] offset:5120
    ds_write_b128 v181, v[40:43] offset:6144
    s_waitcnt lgkmcnt(0)
    s_barrier
    s_branch L_qa_mm_4
L_kn_r_15:
    s_add_u32 s35, s35, 1
    s_cmp_ge_u32 s35, 65536
    s_cbranch_scc1 L_kn_ok_16
    s_sleep 2
    s_branch L_kn_14
L_qa_r_17:
    s_mov_b32 s35, 0
L_qa_l_19:
    s_add_u32 s35, s35, 1
    s_cmp_ge_u32 s35, 65536
    s_cbranch_scc1 L_qa_ok_18
    buffer_load_dwordx4 v[16:19], v1, s[8:11], s26 offen sc1
    buffer_load_dwordx4 v[20:23], v1, s[8:11], s26 offen offset:1024 sc1
    buffer_load_dwordx4 v[24:27], v1, s[8:11], s27 offen sc1
    buffer_load_dwordx4 v[28:31], v1, s[8:11], s27 offen offset:1024 sc1
    buffer_load_dwordx4 v[32:35], v1, s[8:11], s28 offen sc1
    buffer_load_dwordx4 v[36:39], v1, s[8:11], s28 offen offset:1024 sc1
    buffer_load_dwordx4 v[40:43], v1, s[8:11], s53 offen sc1
    buffer_load_dwordx4 v[44:47], v1, s[8:11], s53 offen offset:1024 sc1
    s_waitcnt vmcnt(0)
    v_max3_u32 v216, v16, v17, v18
    v_max3_u32 v216, v216, v19, v20
    v_max3_u32 v216, v216, v21, v22
    v_max3_u32 v216, v216, v23, v24
    v_max3_u32 v216, v216, v25, v26
    v_max3_u32 v216, v216, v27, v28
    v_max3_u32 v216, v216, v29, v30
    v_max3_u32 v216, v216, v31, v32
    v_max3_u32 v216, v216, v33, v34
    v_max3_u32 v216, v216, v35, v36
    v_max3_u32 v216, v216, v37, v38
    v_max3_u32 v216, v216, v39, v40
    v_max3_u32 v216, v216, v41, v42
    v_max3_u32 v216, v216, v43, v44
    v_max3_u32 v216, v216, v45, v46
    v_max_u32 v216, v216, v47
    v_cmp_eq_u32 vcc, -1, v216
    s_nop 1
    s_cmp_lg_u64 vcc, 0
    s_cbranch_scc1 L_qa_l_19
    s_branch L_qa_ok_18
L_kv_r_20:
    s_mov_b32 s35, 0
L_kv_l_22:
    s_add_u32 s35, s35, 1
    s_cmp_ge_u32 s35, 65536
    s_cbranch_scc1 L_kv_ok_21
    s_mov_b32 s39, s37
    s_mov_b32 s40, s38
    buffer_load_dwordx4 v[152:155], v1, s[8:11], s39 offen sc1
    buffer_load_dwordx4 v[156:159], v1, s[8:11], s39 offen offset:1024 sc1
    buffer_load_dwordx4 v[160:163], v1, s[8:11], s40 offen sc1
    buffer_load_dwordx4 v[164:167], v1, s[8:11], s40 offen offset:1024 sc1
    s_add_u32 s39, s39, 2048
    s_add_u32 s40, s40, 2048
    buffer_load_dwordx4 v[168:171], v1, s[8:11], s39 offen sc1
    buffer_load_dwordx4 v[172:175], v1, s[8:11], s39 offen offset:1024 sc1
    buffer_load_dwordx4 v[176:179], v1, s[8:11], s40 offen sc1
    buffer_load_dwordx4 v[180:183], v1, s[8:11], s40 offen offset:1024 sc1
    s_add_u32 s39, s39, 2048
    s_add_u32 s40, s40, 2048
    buffer_load_dwordx4 v[184:187], v1, s[8:11], s39 offen sc1
    buffer_load_dwordx4 v[188:191], v1, s[8:11], s39 offen offset:1024 sc1
    buffer_load_dwordx4 v[192:195], v1, s[8:11], s40 offen sc1
    buffer_load_dwordx4 v[196:199], v1, s[8:11], s40 offen offset:1024 sc1
    s_add_u32 s39, s39, 2048
    s_add_u32 s40, s40, 2048
    s_waitcnt vmcnt(0)
    v_max3_u32 v216, v152, v153, v154
    v_max3_u32 v216, v216, v155, v156
    v_max3_u32 v216, v216, v157, v158
    v_max3_u32 v216, v216, v159, v160
    v_max3_u32 v216, v216, v161, v162
    v_max3_u32 v216, v216, v163, v164
    v_max3_u32 v216, v216, v165, v166
    v_max3_u32 v216, v216, v167, v168
    v_max3_u32 v216, v216, v169, v170
    v_max3_u32 v216, v216, v171, v172
    v_max3_u32 v216, v216, v173, v174
    v_max3_u32 v216, v216, v175, v176
    v_max3_u32 v216, v216, v177, v178
    v_max3_u32 v216, v216, v179, v180
    v_max3_u32 v216, v216, v181, v182
    v_max3_u32 v216, v216, v183, v184
    v_max3_u32 v216, v216, v185, v186
    v_max3_u32 v216, v216, v187, v188
    v_max3_u32 v216, v216, v189, v190
    v_max3_u32 v216, v216, v191, v192
    v_max3_u32 v216, v216, v193, v194
    v_max3_u32 v216, v216, v195, v196
    v_max3_u32 v216, v216, v197, v198
    v_max_u32 v216, v216, v199
    v_cmp_eq_u32 vcc, -1, v216
    s_nop 1
    s_cmp_lg_u64 vcc, 0
    s_cbranch_scc1 L_kv_l_22
    s_branch L_kv_ok_21
L_aa_slow_25:
    buffer_load_dwordx4 v[16:19], v1, s[8:11], s26 offen sc1
    buffer_load_dwordx4 v[20:23], v1, s[8:11], s26 offen offset:1024 sc1
    v_cmp_eq_u32 vcc, 1, v3
    v_mov_b32 v216, 0xff800000
    s_add_u32 s22, s30, 720896
    s_mov_b32 s29, 0
    s_mov_b32 s35, 0
    s_waitcnt vmcnt(0)
    v_cndmask_b32 v22, v22, 0, vcc
    v_cndmask_b32 v23, v23, 0, vcc
L_aa_s1_26:
    buffer_load_dwordx4 v[152:155], v1, s[8:11], s22 offen sc1
    buffer_load_dwordx4 v[156:159], v1, s[8:11], s22 offen offset:1024 sc1
    s_waitcnt vmcnt(0)
    s_add_u32 s35, s35, 1
    s_cmp_ge_u32 s35, 65536
    s_cbranch_scc1 L_aa_s1r_28
    v_max3_u32 v217, v152, v153, v154
    v_max3_u32 v217, v217, v155, v156
    v_max3_u32 v217, v217, v157, v158
    v_max_u32 v217, v217, v159
    v_cmp_eq_u32 vcc, -1, v217
    s_nop 1
    s_cmp_lg_u64 vcc, 0
    s_cbranch_scc1 L_aa_s1_26
L_aa_s1r_28:
    s_add_u32 s22, s22, 2048
    v_mfma_f32_32x32x16_bf16 v[48:63], v[152:155], v[16:19], 0
    v_mfma_f32_32x32x16_bf16 v[48:63], v[156:159], v[20:23], v[48:63]
    s_nop 15
    v_max3_f32 v216, v216, v48, v49
    v_max3_f32 v216, v216, v50, v51
    v_max3_f32 v216, v216, v52, v53
    v_max3_f32 v216, v216, v54, v55
    v_max3_f32 v216, v216, v56, v57
    v_max3_f32 v216, v216, v58, v59
    v_max3_f32 v216, v216, v60, v61
    v_max3_f32 v216, v216, v62, v63
    s_add_u32 s29, s29, 1
    s_cmp_lt_u32 s29, 64
    s_cbranch_scc1 L_aa_s1_26
    v_mov_b32 v217, v216
    s_nop 1
    v_permlane32_swap_b32 v216, v217
    s_nop 1
    v_max_f32 v216, v216, v217
    s_mov_b32 exec_lo, 0
    v_and_b32 v217, 0xffff0000, v216
    v_sub_f32 v218, v216, v217
    v_and_b32 v219, 0xffff0000, v218
    v_sub_f32 v218, v218, v219
    v_lshrrev_b32 v217, 16, v217
    v_or_b32 v217, v217, v219
    v_lshrrev_b32 v218, 16, v218
    v_xor_b32 v22, 0x80008000, v217
    v_xor_b32 v23, 0x00008000, v218
    s_mov_b64 exec, -1
    s_add_u32 s22, s30, 720896
    s_add_u32 s23, s30, 851968
    s_mov_b32 s29, 0
    v_mov_b32 v88, 0
    v_mov_b32 v89, 0
    v_mov_b32 v90, 0
    v_mov_b32 v91, 0
    v_mov_b32 v92, 0
    v_mov_b32 v93, 0
    v_mov_b32 v94, 0
    v_mov_b32 v95, 0
    v_mov_b32 v96, 0
    v_mov_b32 v97, 0
    v_mov_b32 v98, 0
    v_mov_b32 v99, 0
    v_mov_b32 v100, 0
    v_mov_b32 v101, 0
    v_mov_b32 v102, 0
    v_mov_b32 v103, 0
L_aa_s2_27:
    buffer_load_dwordx4 v[152:155], v1, s[8:11], s22 offen sc1
    buffer_load_dwordx4 v[156:159], v1, s[8:11], s22 offen offset:1024 sc1
    buffer_load_dwordx4 v[160:163], v1, s[8:11], s23 offen sc1
    buffer_load_dwordx4 v[164:167], v1, s[8:11], s23 offen offset:1024 sc1
    s_waitcnt vmcnt(0)
    s_add_u32 s35, s35, 1
    s_cmp_ge_u32 s35, 65536
    s_cbranch_scc1 L_aa_s2r_29
    v_max3_u32 v217, v152, v153, v154
    v_max3_u32 v217, v217, v155, v156
    v_max3_u32 v217, v217, v157, v158
    v_max3_u32 v217, v217, v159, v160
    v_max3_u32 v217, v217, v161, v162
    v_max3_u32 v217, v217, v163, v164
    v_max3_u32 v217, v217, v165, v166
    v_max_u32 v217, v217, v167
    v_cmp_eq_u32 vcc, -1, v217
    s_nop 1
    s_cmp_lg_u64 vcc, 0
    s_cbranch_scc1 L_aa_s2_27
L_aa_s2r_29:
    s_add_u32 s22, s22, 2048
    s_add_u32 s23, s23, 2048
    v_mfma_f32_32x32x16_bf16 v[48:63], v[152:155], v[16:19], 0
    v_mfma_f32_32x32x16_bf16 v[48:63], v[156:159], v[20:23], v[48:63]
    s_nop 15
    v_exp_f32 v48, v48
    v_exp_f32 v49, v49
    v_exp_f32 v50, v50
    v_exp_f32 v51, v51
    v_exp_f32 v52, v52
    v_exp_f32 v53, v53
    v_exp_f32 v54, v54
    v_exp_f32 v55, v55
    v_exp_f32 v56, v56
    v_exp_f32 v57, v57
    v_exp_f32 v58, v58
    v_exp_f32 v59, v59
    v_exp_f32 v60, v60
    v_exp_f32 v61, v61
    v_exp_f32 v62, v62
    v_exp_f32 v63, v63
    s_nop 0
    v_cvt_pk_bf16_f32 v80, v48, v49
    v_cvt_pk_bf16_f32 v81, v50, v51
    v_cvt_pk_bf16_f32 v82, v52, v53
    v_cvt_pk_bf16_f32 v83, v54, v55
    v_cvt_pk_bf16_f32 v84, v56, v57
    v_cvt_pk_bf16_f32 v85, v58, v59
    v_cvt_pk_bf16_f32 v86, v60, v61
    v_cvt_pk_bf16_f32 v87, v62, v63
    s_nop 1
    v_mfma_f32_32x32x16_bf16 v[88:103], v[160:163], v[80:83], v[88:103]
    v_mfma_f32_32x32x16_bf16 v[88:103], v[164:167], v[84:87], v[88:103]
    s_add_u32 s29, s29, 1
    s_cmp_lt_u32 s29, 64
    s_cbranch_scc1 L_aa_s2_27
    s_nop 15
    v_mov_b32 v218, v100
    v_mov_b32 v219, v100
    s_nop 1
    v_permlane32_swap_b32 v218, v219
    s_nop 1
    v_rcp_f32 v218, v219
    s_nop 0
    s_branch L_aa_norm_24
L_ho_r_32:
    s_add_u32 s35, s35, 1
    s_cmp_ge_u32 s35, 65536
    s_cbranch_scc1 L_ho_ok_33
    s_sleep 1
    s_branch L_ho_31
L_ofr_r_39:
    s_add_u32 s35, s35, 1
    s_cmp_ge_u32 s35, 65536
    s_cbranch_scc1 L_ofr_ok_40
    s_sleep 1
    s_branch L_ofr_38
L_op_redo_36:
    s_cmp_lg_u32 s53, 0
    s_cbranch_scc1 L_op_ok_37
    s_mov_b32 s53, 1
    s_barrier
    s_mov_b32 s35, 0
L_ofr_38:
    buffer_load_dwordx4 v[16:19], v1, s[8:11], s27 offen offset:0 sc1
    buffer_load_dwordx4 v[20:23], v1, s[8:11], s27 offen offset:1024 sc1
    buffer_load_dwordx4 v[24:27], v1, s[8:11], s27 offen offset:2048 sc1
    buffer_load_dwordx4 v[28:31], v1, s[8:11], s27 offen offset:3072 sc1
    s_add_u32 s29, s27, 4096
    buffer_load_dwordx4 v[32:35], v1, s[8:11], s29 offen offset:0 sc1
    buffer_load_dwordx4 v[36:39], v1, s[8:11], s29 offen offset:1024 sc1
    buffer_load_dwordx4 v[40:43], v1, s[8:11], s29 offen offset:2048 sc1
    buffer_load_dwordx4 v[44:47], v1, s[8:11], s29 offen offset:3072 sc1
    s_waitcnt vmcnt(0)
    v_max3_u32 v180, v16, v17, v18
    v_max3_u32 v180, v180, v19, v20
    v_max3_u32 v180, v180, v21, v22
    v_max3_u32 v180, v180, v23, v24
    v_max3_u32 v180, v180, v25, v26
    v_max3_u32 v180, v180, v27, v28
    v_max3_u32 v180, v180, v29, v30
    v_max3_u32 v180, v180, v31, v32
    v_max3_u32 v180, v180, v33, v34
    v_max3_u32 v180, v180, v35, v36
    v_max3_u32 v180, v180, v37, v38
    v_max3_u32 v180, v180, v39, v40
    v_max3_u32 v180, v180, v41, v42
    v_max3_u32 v180, v180, v43, v44
    v_max3_u32 v180, v180, v45, v46
    v_max_u32 v180, v180, v47
    v_cmp_eq_u32 vcc, -1, v180
    s_nop 1
    s_cmp_lg_u64 vcc, 0
    s_cbranch_scc1 L_ofr_r_39
L_ofr_ok_40:
    ds_write_b128 v176, v[16:19] offset:0
    ds_write_b128 v176, v[20:23] offset:1024
    ds_write_b128 v176, v[24:27] offset:2048
    ds_write_b128 v176, v[28:31] offset:3072
    ds_write_b128 v176, v[32:35] offset:4096
    ds_write_b128 v176, v[36:39] offset:5120
    ds_write_b128 v176, v[40:43] offset:6144
    ds_write_b128 v176, v[44:47] offset:7168
    s_waitcnt lgkmcnt(0)
    s_barrier
    s_branch L_op_mm_35
L_st_r_43:
    s_add_u32 s35, s35, 1
    s_cmp_ge_u32 s35, 65536
    s_cbranch_scc1 L_st_ok_44
    s_sleep 1
    s_branch L_st_42
L_qb_redo_46:
    s_cmp_lg_u32 s35, 0
    s_cbranch_scc1 L_qb_ok_47
    s_waitcnt lgkmcnt(0)
L_qb_r2_48:
    s_add_u32 s35, s35, 1
    s_cmp_ge_u32 s35, 65536
    s_cbranch_scc1 L_qb_mm_45
    buffer_load_dwordx4 v[16:19], v1, s[8:11], s21 offen offset:0 sc1
    buffer_load_dwordx4 v[20:23], v1, s[8:11], s21 offen offset:1024 sc1
    buffer_load_dwordx4 v[24:27], v1, s[8:11], s21 offen offset:2048 sc1
    buffer_load_dwordx4 v[28:31], v1, s[8:11], s21 offen offset:3072 sc1
    s_add_u32 s29, s21, 4096
    buffer_load_dwordx4 v[32:35], v1, s[8:11], s29 offen offset:0 sc1
    buffer_load_dwordx4 v[36:39], v1, s[8:11], s29 offen offset:1024 sc1
    buffer_load_dwordx4 v[40:43], v1, s[8:11], s29 offen offset:2048 sc1
    buffer_load_dwordx4 v[44:47], v1, s[8:11], s29 offen offset:3072 sc1
    s_add_u32 s29, s21, 8192
    buffer_load_dwordx4 v[48:51], v1, s[8:11], s29 offen offset:0 sc1
    buffer_load_dwordx4 v[52:55], v1, s[8:11], s29 offen offset:1024 sc1
    buffer_load_dwordx4 v[56:59], v1, s[8:11], s29 offen offset:2048 sc1
    buffer_load_dwordx4 v[60:63], v1, s[8:11], s29 offen offset:3072 sc1
    s_add_u32 s29, s21, 12288
    buffer_load_dwordx4 v[64:67], v1, s[8:11], s29 offen offset:0 sc1
    buffer_load_dwordx4 v[68:71], v1, s[8:11], s29 offen offset:1024 sc1
    buffer_load_dwordx4 v[72:75], v1, s[8:11], s29 offen offset:2048 sc1
    buffer_load_dwordx4 v[76:79], v1, s[8:11], s29 offen offset:3072 sc1
    s_add_u32 s29, s21, 16384
    buffer_load_dwordx4 v[80:83], v1, s[8:11], s29 offen offset:0 sc1
    buffer_load_dwordx4 v[84:87], v1, s[8:11], s29 offen offset:1024 sc1
    buffer_load_dwordx4 v[88:91], v1, s[8:11], s29 offen offset:2048 sc1
    buffer_load_dwordx4 v[92:95], v1, s[8:11], s29 offen offset:3072 sc1
    s_add_u32 s29, s21, 20480
    buffer_load_dwordx4 v[96:99], v1, s[8:11], s29 offen offset:0 sc1
    buffer_load_dwordx4 v[100:103], v1, s[8:11], s29 offen offset:1024 sc1
    buffer_load_dwordx4 v[104:107], v1, s[8:11], s29 offen offset:2048 sc1
    buffer_load_dwordx4 v[108:111], v1, s[8:11], s29 offen offset:3072 sc1
    s_add_u32 s29, s21, 24576
    buffer_load_dwordx4 v[112:115], v1, s[8:11], s29 offen offset:0 sc1
    buffer_load_dwordx4 v[116:119], v1, s[8:11], s29 offen offset:1024 sc1
    buffer_load_dwordx4 v[120:123], v1, s[8:11], s29 offen offset:2048 sc1
    buffer_load_dwordx4 v[124:127], v1, s[8:11], s29 offen offset:3072 sc1
    s_waitcnt vmcnt(0)
    v_max3_u32 v248, v16, v17, v18
    v_max3_u32 v248, v248, v19, v20
    v_max3_u32 v248, v248, v21, v22
    v_max3_u32 v248, v248, v23, v24
    v_max3_u32 v248, v248, v25, v26
    v_max3_u32 v248, v248, v27, v28
    v_max3_u32 v248, v248, v29, v30
    v_max3_u32 v248, v248, v31, v32
    v_max3_u32 v248, v248, v33, v34
    v_max3_u32 v248, v248, v35, v36
    v_max3_u32 v248, v248, v37, v38
    v_max3_u32 v248, v248, v39, v40
    v_max3_u32 v248, v248, v41, v42
    v_max3_u32 v248, v248, v43, v44
    v_max3_u32 v248, v248, v45, v46
    v_max3_u32 v248, v248, v47, v48
    v_max3_u32 v248, v248, v49, v50
    v_max3_u32 v248, v248, v51, v52
    v_max3_u32 v248, v248, v53, v54
    v_max3_u32 v248, v248, v55, v56
    v_max3_u32 v248, v248, v57, v58
    v_max3_u32 v248, v248, v59, v60
    v_max3_u32 v248, v248, v61, v62
    v_max3_u32 v248, v248, v63, v64
    v_max3_u32 v248, v248, v65, v66
    v_max3_u32 v248, v248, v67, v68
    v_max3_u32 v248, v248, v69, v70
    v_max3_u32 v248, v248, v71, v72
    v_max3_u32 v248, v248, v73, v74
    v_max3_u32 v248, v248, v75, v76
    v_max3_u32 v248, v248, v77, v78
    v_max3_u32 v248, v248, v79, v80
    v_max3_u32 v248, v248, v81, v82
    v_max3_u32 v248, v248, v83, v84
    v_max3_u32 v248, v248, v85, v86
    v_max3_u32 v248, v248, v87, v88
    v_max3_u32 v248, v248, v89, v90
    v_max3_u32 v248, v248, v91, v92
    v_max3_u32 v248, v248, v93, v94
    v_max3_u32 v248, v248, v95, v96
    v_max3_u32 v248, v248, v97, v98
    v_max3_u32 v248, v248, v99, v100
    v_max3_u32 v248, v248, v101, v102
    v_max3_u32 v248, v248, v103, v104
    v_max3_u32 v248, v248, v105, v106
    v_max3_u32 v248, v248, v107, v108
    v_max3_u32 v248, v248, v109, v110
    v_max3_u32 v248, v248, v111, v112
    v_max3_u32 v248, v248, v113, v114
    v_max3_u32 v248, v248, v115, v116
    v_max3_u32 v248, v248, v117, v118
    v_max3_u32 v248, v248, v119, v120
    v_max3_u32 v248, v248, v121, v122
    v_max3_u32 v248, v248, v123, v124
    v_max3_u32 v248, v248, v125, v126
    v_max_u32 v248, v248, v127
    v_cmp_eq_u32 vcc, -1, v248
    s_nop 1
    s_cmp_lg_u64 vcc, 0
    s_cbranch_scc1 L_qb_r2_48
    s_branch L_qb_mm_45
L_kb_r_50:
    s_add_u32 s35, s35, 1
    s_cmp_ge_u32 s35, 65536
    s_cbranch_scc1 L_kb_ok_51
    s_sleep 1
    s_branch L_kb_49
L_nbr_r_78:
    s_add_u32 s35, s35, 1
    s_cmp_ge_u32 s35, 65536
    s_cbranch_scc1 L_nbr_ok_79
    s_sleep 1
    s_branch L_nbr_77
L_nbr_r_82:
    s_add_u32 s35, s35, 1
    s_cmp_ge_u32 s35, 65536
    s_cbranch_scc1 L_nbr_ok_83
    s_sleep 1
    s_branch L_nbr_81
L_nbr_r_86:
    s_add_u32 s35, s35, 1
    s_cmp_ge_u32 s35, 65536
    s_cbranch_scc1 L_nbr_ok_87
    s_sleep 1
    s_branch L_nbr_85
L_nbr_r_90:
    s_add_u32 s35, s35, 1
    s_cmp_ge_u32 s35, 65536
    s_cbranch_scc1 L_nbr_ok_91
    s_sleep 1
    s_branch L_nbr_89
L_nbr_r_94:
    s_add_u32 s35, s35, 1
    s_cmp_ge_u32 s35, 65536
    s_cbranch_scc1 L_nbr_ok_95
    s_sleep 1
    s_branch L_nbr_93
L_nbr_r_98:
    s_add_u32 s35, s35, 1
    s_cmp_ge_u32 s35, 65536
    s_cbranch_scc1 L_nbr_ok_99
    s_sleep 1
    s_branch L_nbr_97
L_nbr_r_102:
    s_add_u32 s35, s35, 1
    s_cmp_ge_u32 s35, 65536
    s_cbranch_scc1 L_nbr_ok_103
    s_sleep 1
    s_branch L_nbr_101
L_nbr_r_106:
    s_add_u32 s35, s35, 1
    s_cmp_ge_u32 s35, 65536
    s_cbranch_scc1 L_nbr_ok_107
    s_sleep 1
    s_branch L_nbr_105
L_ab_x_57:
    v_mfma_f32_32x32x16_bf16 v[64:79], v[156:159], v[60:63], v[64:79]
    s_branch L_ab_cu_66
L_ab_x_58:
    v_mfma_f32_32x32x16_bf16 v[64:79], v[172:175], v[60:63], v[64:79]
    s_branch L_ab_cu_67
L_ab_x_59:
    v_mfma_f32_32x32x16_bf16 v[64:79], v[188:191], v[60:63], v[64:79]
    s_branch L_ab_cu_68
L_ab_x_60:
    v_mfma_f32_32x32x16_bf16 v[64:79], v[156:159], v[60:63], v[64:79]
    s_branch L_ab_cu_69
L_ab_x_61:
    v_mfma_f32_32x32x16_bf16 v[64:79], v[172:175], v[60:63], v[64:79]
    s_branch L_ab_cu_70
L_ab_x_62:
    v_mfma_f32_32x32x16_bf16 v[64:79], v[188:191], v[60:63], v[64:79]
    s_branch L_ab_cu_71
L_ab_x_63:
    v_mfma_f32_32x32x16_bf16 v[64:79], v[156:159], v[60:63], v[64:79]
    s_branch L_ab_cu_72
L_ab_x_64:
    v_mfma_f32_32x32x16_bf16 v[64:79], v[172:175], v[60:63], v[64:79]
    s_branch L_ab_cu_73
L_ab_cu_66:
    s_add_u32 s48, s50, 4096
    s_addc_u32 s49, s51, 0
    global_load_dwordx4 a[128:131], v1, s[48:49] offset:0
    global_load_dwordx4 a[132:135], v1, s[48:49] offset:1024
    global_load_dwordx4 a[136:139], v1, s[48:49] offset:2048
    global_load_dwordx4 a[140:143], v1, s[48:49] offset:3072
L_ab_cu_67:
    s_add_u32 s48, s50, 8192
    s_addc_u32 s49, s51, 0
    global_load_dwordx4 a[144:147], v1, s[48:49] offset:0
    global_load_dwordx4 a[148:151], v1, s[48:49] offset:1024
    global_load_dwordx4 a[152:155], v1, s[48:49] offset:2048
    global_load_dwordx4 a[156:159], v1, s[48:49] offset:3072
L_ab_cu_68:
    s_add_u32 s48, s50, 12288
    s_addc_u32 s49, s51, 0
    global_load_dwordx4 a[160:163], v1, s[48:49] offset:0
    global_load_dwordx4 a[164:167], v1, s[48:49] offset:1024
    global_load_dwordx4 a[168:171], v1, s[48:49] offset:2048
    global_load_dwordx4 a[172:175], v1, s[48:49] offset:3072
L_ab_cu_69:
    s_add_u32 s48, s50, 16384
    s_addc_u32 s49, s51, 0
    global_load_dwordx4 a[176:179], v1, s[48:49] offset:0
    global_load_dwordx4 a[180:183], v1, s[48:49] offset:1024
    global_load_dwordx4 a[184:187], v1, s[48:49] offset:2048
    global_load_dwordx4 a[188:191], v1, s[48:49] offset:3072
L_ab_cu_70:
    s_add_u32 s48, s50, 20480
    s_addc_u32 s49, s51, 0
    global_load_dwordx4 a[192:195], v1, s[48:49] offset:0
    global_load_dwordx4 a[196:199], v1, s[48:49] offset:1024
    global_load_dwordx4 a[200:203], v1, s[48:49] offset:2048
    global_load_dwordx4 a[204:207], v1, s[48:49] offset:3072
L_ab_cu_71:
    s_add_u32 s48, s50, 24576
    s_addc_u32 s49, s51, 0
    global_load_dwordx4 a[208:211], v1, s[48:49] offset:0
    global_load_dwordx4 a[212:215], v1, s[48:49] offset:1024
    global_load_dwordx4 a[216:219], v1, s[48:49] offset:2048
    global_load_dwordx4 a[220:223], v1, s[48:49] offset:3072
L_ab_cu_72:
    s_add_u32 s48, s50, 28672
    s_addc_u32 s49, s51, 0
    global_load_dwordx4 a[224:227], v1, s[48:49] offset:0
    global_load_dwordx4 a[228:231], v1, s[48:49] offset:1024
    global_load_dwordx4 a[232:235], v1, s[48:49] offset:2048
    global_load_dwordx4 a[236:239], v1, s[48:49] offset:3072
L_ab_cu_73:
    s_branch L_ab_fin_54
L_ab_slow_55:
    s_cmp_eq_u64 s[24:25], 0
    s_cbranch_scc1 L_ab_mx_75
    s_bitcmp1_b32 s29, 1
    s_cbranch_scc1 L_ab_mx_75
    s_or_b32 s29, s29, 2
    s_lshl_b32 s24, s4, 2
    s_lshl_b32 s22, s24, 11
    s_lshl_b32 s23, s5, 17
    s_add_u32 s22, s22, s23
    s_add_u32 s22, s22, s30
    s_add_u32 s23, s22, 11059200
    s_add_u32 s22, s22, 8962048
    v_add_u32 v14, 86016, v1
    s_cmp_lt_u32 s24, 8
    s_cbranch_scc1 L_ab_rs_76
    s_mov_b32 s35, 0
L_nbr_77:
    buffer_load_dwordx4 v[112:115], v1, s[8:11], s22 offen sc1
    buffer_load_dwordx4 v[116:119], v1, s[8:11], s22 offen offset:1024 sc1
    buffer_load_dwordx4 v[120:123], v1, s[8:11], s23 offen sc1
    buffer_load_dwordx4 v[124:127], v1, s[8:11], s23 offen offset:1024 sc1
    s_waitcnt vmcnt(0)
    v_max3_u32 v13, v112, v113, v114
    v_max3_u32 v13, v13, v115, v116
    v_max3_u32 v13, v13, v117, v118
    v_max3_u32 v13, v13, v119, v120
    v_max3_u32 v13, v13, v121, v122
    v_max3_u32 v13, v13, v123, v124
    v_max3_u32 v13, v13, v125, v126
    v_max_u32 v13, v13, v127
    v_cmp_eq_u32 vcc, -1, v13
    s_nop 1
    s_cmp_lg_u64 vcc, 0
    s_cbranch_scc1 L_nbr_r_78
L_nbr_ok_79:
    ds_write_b128 v14, v[112:115] offset:0
    ds_write_b128 v14, v[116:119] offset:1024
    ds_write_b128 v14, v[120:123] offset:2048
    ds_write_b128 v14, v[124:127] offset:3072
    s_waitcnt lgkmcnt(0)
L_ab_rs_76:
    s_add_u32 s22, s22, 2048
    s_add_u32 s23, s23, 2048
    s_cmp_lt_u32 s24, 7
    s_cbranch_scc1 L_ab_rs_80
    s_mov_b32 s35, 0
L_nbr_81:
    buffer_load_dwordx4 v[112:115], v1, s[8:11], s22 offen sc1
    buffer_load_dwordx4 v[116:119], v1, s[8:11], s22 offen offset:1024 sc1
    buffer_load_dwordx4 v[120:123], v1, s[8:11], s23 offen sc1
    buffer_load_dwordx4 v[124:127], v1, s[8:11], s23 offen offset:1024 sc1
    s_waitcnt vmcnt(0)
    v_max3_u32 v13, v112, v113, v114
    v_max3_u32 v13, v13, v115, v116
    v_max3_u32 v13, v13, v117, v118
    v_max3_u32 v13, v13, v119, v120
    v_max3_u32 v13, v13, v121, v122
    v_max3_u32 v13, v13, v123, v124
    v_max3_u32 v13, v13, v125, v126
    v_max_u32 v13, v13, v127
    v_cmp_eq_u32 vcc, -1, v13
    s_nop 1
    s_cmp_lg_u64 vcc, 0
    s_cbranch_scc1 L_nbr_r_82
L_nbr_ok_83:
    ds_write_b128 v14, v[112:115] offset:4096
    ds_write_b128 v14, v[116:119] offset:5120
    ds_write_b128 v14, v[120:123] offset:6144
    ds_write_b128 v14, v[124:127] offset:7168
    s_waitcnt lgkmcnt(0)
L_ab_rs_80:
    s_add_u32 s22, s22, 2048
    s_add_u32 s23, s23, 2048
    s_cmp_lt_u32 s24, 6
    s_cbranch_scc1 L_ab_rs_84
    s_mov_b32 s35, 0
L_nbr_85:
    buffer_load_dwordx4 v[112:115], v1, s[8:11], s22 offen sc1
    buffer_load_dwordx4 v[116:119], v1, s[8:11], s22 offen offset:1024 sc1
    buffer_load_dwordx4 v[120:123], v1, s[8:11], s23 offen sc1
    buffer_load_dwordx4 v[124:127], v1, s[8:11], s23 offen offset:1024 sc1
    s_waitcnt vmcnt(0)
    v_max3_u32 v13, v112, v113, v114
    v_max3_u32 v13, v13, v115, v116
    v_max3_u32 v13, v13, v117, v118
    v_max3_u32 v13, v13, v119, v120
    v_max3_u32 v13, v13, v121, v122
    v_max3_u32 v13, v13, v123, v124
    v_max3_u32 v13, v13, v125, v126
    v_max_u32 v13, v13, v127
    v_cmp_eq_u32 vcc, -1, v13
    s_nop 1
    s_cmp_lg_u64 vcc, 0
    s_cbranch_scc1 L_nbr_r_86
L_nbr_ok_87:
    ds_write_b128 v14, v[112:115] offset:8192
    ds_write_b128 v14, v[116:119] offset:9216
    ds_write_b128 v14, v[120:123] offset:10240
    ds_write_b128 v14, v[124:127] offset:11264
    s_waitcnt lgkmcnt(0)
L_ab_rs_84:
    s_add_u32 s22, s22, 2048
    s_add_u32 s23, s23, 2048
    s_cmp_lt_u32 s24, 5
    s_cbranch_scc1 L_ab_rs_88
    s_mov_b32 s35, 0
L_nbr_89:
    buffer_load_dwordx4 v[112:115], v1, s[8:11], s22 offen sc1
    buffer_load_dwordx4 v[116:119], v1, s[8:11], s22 offen offset:1024 sc1
    buffer_load_dwordx4 v[120:123], v1, s[8:11], s23 offen sc1
    buffer_load_dwordx4 v[124:127], v1, s[8:11], s23 offen offset:1024 sc1
    s_waitcnt vmcnt(0)
    v_max3_u32 v13, v112, v113, v114
    v_max3_u32 v13, v13, v115, v116
    v_max3_u32 v13, v13, v117, v118
    v_max3_u32 v13, v13, v119, v120
    v_max3_u32 v13, v13, v121, v122
    v_max3_u32 v13, v13, v123, v124
    v_max3_u32 v13, v13, v125, v126
    v_max_u32 v13, v13, v127
    v_cmp_eq_u32 vcc, -1, v13
    s_nop 1
    s_cmp_lg_u64 vcc, 0
    s_cbranch_scc1 L_nbr_r_90
L_nbr_ok_91:
    ds_write_b128 v14, v[112:115] offset:12288
    ds_write_b128 v14, v[116:119] offset:13312
    ds_write_b128 v14, v[120:123] offset:14336
    ds_write_b128 v14, v[124:127] offset:15360
    s_waitcnt lgkmcnt(0)
L_ab_rs_88:
    s_add_u32 s22, s22, 2048
    s_add_u32 s23, s23, 2048
    s_cmp_lt_u32 s24, 4
    s_cbranch_scc1 L_ab_rs_92
    s_mov_b32 s35, 0
L_nbr_93:
    buffer_load_dwordx4 v[112:115], v1, s[8:11], s22 offen sc1
    buffer_load_dwordx4 v[116:119], v1, s[8:11], s22 offen offset:1024 sc1
    buffer_load_dwordx4 v[120:123], v1, s[8:11], s23 offen sc1
    buffer_load_dwordx4 v[124:127], v1, s[8:11], s23 offen offset:1024 sc1
    s_waitcnt vmcnt(0)
    v_max3_u32 v13, v112, v113, v114
    v_max3_u32 v13, v13, v115, v116
    v_max3_u32 v13, v13, v117, v118
    v_max3_u32 v13, v13, v119, v120
    v_max3_u32 v13, v13, v121, v122
    v_max3_u32 v13, v13, v123, v124
    v_max3_u32 v13, v13, v125, v126
    v_max_u32 v13, v13, v127
    v_cmp_eq_u32 vcc, -1, v13
    s_nop 1
    s_cmp_lg_u64 vcc, 0
    s_cbranch_scc1 L_nbr_r_94
L_nbr_ok_95:
    ds_write_b128 v14, v[112:115] offset:16384
    ds_write_b128 v14, v[116:119] offset:17408
    ds_write_b128 v14, v[120:123] offset:18432
    ds_write_b128 v14, v[124:127] offset:19456
    s_waitcnt lgkmcnt(0)
L_ab_rs_92:
    s_add_u32 s22, s22, 2048
    s_add_u32 s23, s23, 2048
    s_cmp_lt_u32 s24, 3
    s_cbranch_scc1 L_ab_rs_96
    s_mov_b32 s35, 0
L_nbr_97:
    buffer_load_dwordx4 v[112:115], v1, s[8:11], s22 offen sc1
    buffer_load_dwordx4 v[116:119], v1, s[8:11], s22 offen offset:1024 sc1
    buffer_load_dwordx4 v[120:123], v1, s[8:11], s23 offen sc1
    buffer_load_dwordx4 v[124:127], v1, s[8:11], s23 offen offset:1024 sc1
    s_waitcnt vmcnt(0)
    v_max3_u32 v13, v112, v113, v114
    v_max3_u32 v13, v13, v115, v116
    v_max3_u32 v13, v13, v117, v118
    v_max3_u32 v13, v13, v119, v120
    v_max3_u32 v13, v13, v121, v122
    v_max3_u32 v13, v13, v123, v124
    v_max3_u32 v13, v13, v125, v126
    v_max_u32 v13, v13, v127
    v_cmp_eq_u32 vcc, -1, v13
    s_nop 1
    s_cmp_lg_u64 vcc, 0
    s_cbranch_scc1 L_nbr_r_98
L_nbr_ok_99:
    ds_write_b128 v14, v[112:115] offset:20480
    ds_write_b128 v14, v[116:119] offset:21504
    ds_write_b128 v14, v[120:123] offset:22528
    ds_write_b128 v14, v[124:127] offset:23552
    s_waitcnt lgkmcnt(0)
L_ab_rs_96:
    s_add_u32 s22, s22, 2048
    s_add_u32 s23, s23, 2048
    s_cmp_lt_u32 s24, 2
    s_cbranch_scc1 L_ab_rs_100
    s_mov_b32 s35, 0
L_nbr_101:
    buffer_load_dwordx4 v[112:115], v1, s[8:11], s22 offen sc1
    buffer_load_dwordx4 v[116:119], v1, s[8:11], s22 offen offset:1024 sc1
    buffer_load_dwordx4 v[120:123], v1, s[8:11], s23 offen sc1
    buffer_load_dwordx4 v[124:127], v1, s[8:11], s23 offen offset:1024 sc1
    s_waitcnt vmcnt(0)
    v_max3_u32 v13, v112, v113, v114
    v_max3_u32 v13, v13, v115, v116
    v_max3_u32 v13, v13, v117, v118
    v_max3_u32 v13, v13, v119, v120
    v_max3_u32 v13, v13, v121, v122
    v_max3_u32 v13, v13, v123, v124
    v_max3_u32 v13, v13, v125, v126
    v_max_u32 v13, v13, v127
    v_cmp_eq_u32 vcc, -1, v13
    s_nop 1
    s_cmp_lg_u64 vcc, 0
    s_cbranch_scc1 L_nbr_r_102
L_nbr_ok_103:
    ds_write_b128 v14, v[112:115] offset:24576
    ds_write_b128 v14, v[116:119] offset:25600
    ds_write_b128 v14, v[120:123] offset:26624
    ds_write_b128 v14, v[124:127] offset:27648
    s_waitcnt lgkmcnt(0)
L_ab_rs_100:
    s_add_u32 s22, s22, 2048
    s_add_u32 s23, s23, 2048
    s_cmp_lt_u32 s24, 1
    s_cbranch_scc1 L_ab_rs_104
    s_mov_b32 s35, 0
L_nbr_105:
    buffer_load_dwordx4 v[112:115], v1, s[8:11], s22 offen sc1
    buffer_load_dwordx4 v[116:119], v1, s[8:11], s22 offen offset:1024 sc1
    buffer_load_dwordx4 v[120:123], v1, s[8:11], s23 offen sc1
    buffer_load_dwordx4 v[124:127], v1, s[8:11], s23 offen offset:1024 sc1
    s_waitcnt vmcnt(0)
    v_max3_u32 v13, v112, v113, v114
    v_max3_u32 v13, v13, v115, v116
    v_max3_u32 v13, v13, v117, v118
    v_max3_u32 v13, v13, v119, v120
    v_max3_u32 v13, v13, v121, v122
    v_max3_u32 v13, v13, v123, v124
    v_max3_u32 v13, v13, v125, v126
    v_max_u32 v13, v13, v127
    v_cmp_eq_u32 vcc, -1, v13
    s_nop 1
    s_cmp_lg_u64 vcc, 0
    s_cbranch_scc1 L_nbr_r_106
L_nbr_ok_107:
    ds_write_b128 v14, v[112:115] offset:28672
    ds_write_b128 v14, v[116:119] offset:29696
    ds_write_b128 v14, v[120:123] offset:30720
    ds_write_b128 v14, v[124:127] offset:31744
    s_waitcnt lgkmcnt(0)
L_ab_rs_104:
    s_add_u32 s22, s22, 2048
    s_add_u32 s23, s23, 2048
    s_branch L_ab_main_53
L_ab_mx_75:
    s_cmp_eq_u64 vcc, 0
    s_cbranch_scc1 L_ab_norm_56
    s_bitcmp1_b32 s29, 0
    s_cbranch_scc1 L_ab_norm_56
    v_cmp_eq_u32 vcc, 1, v3
    v_mov_b32 v4, 0xff800000
    s_or_b32 s29, s29, 1
    v_cndmask_b32 v230, v230, 0, vcc
    v_cndmask_b32 v231, v231, 0, vcc
    ds_read_b128 v[144:147], v11 offset:32768
    ds_read_b128 v[148:151], v11 offset:33792
    s_waitcnt lgkmcnt(0)
    v_mfma_f32_32x32x16_bf16 v[24:39], v[144:147], v[224:227], v[80:95]
    v_mfma_f32_32x32x16_bf16 v[24:39], v[148:151], v[228:231], v[24:39]
    s_nop 15
    v_max3_f32 v4, v4, v24, v25
    v_max3_f32 v4, v4, v26, v27
    v_max3_f32 v4, v4, v28, v29
    v_max3_f32 v4, v4, v30, v31
    v_max3_f32 v4, v4, v32, v33
    v_max3_f32 v4, v4, v34, v35
    v_max3_f32 v4, v4, v36, v37
    v_max3_f32 v4, v4, v38, v39
    s_cmp_eq_u32 s28, 0
    s_cbranch_scc1 L_ab_sm_74
    ds_read_b128 v[144:147], v11 offset:28672
    ds_read_b128 v[148:151], v11 offset:29696
    s_waitcnt lgkmcnt(0)
    v_mfma_f32_32x32x16_bf16 v[24:39], v[144:147], v[224:227], 0
    v_mfma_f32_32x32x16_bf16 v[24:39], v[148:151], v[228:231], v[24:39]
    s_nop 15
    v_max3_f32 v4, v4, v24, v25
    v_max3_f32 v4, v4, v26, v27
    v_max3_f32 v4, v4, v28, v29
    v_max3_f32 v4, v4, v30, v31
    v_max3_f32 v4, v4, v32, v33
    v_max3_f32 v4, v4, v34, v35
    v_max3_f32 v4, v4, v36, v37
    v_max3_f32 v4, v4, v38, v39
    s_cmp_eq_u32 s28, 1
    s_cbranch_scc1 L_ab_sm_74
    ds_read_b128 v[144:147], v11 offset:24576
    ds_read_b128 v[148:151], v11 offset:25600
    s_waitcnt lgkmcnt(0)
    v_mfma_f32_32x32x16_bf16 v[24:39], v[144:147], v[224:227], 0
    v_mfma_f32_32x32x16_bf16 v[24:39], v[148:151], v[228:231], v[24:39]
    s_nop 15
    v_max3_f32 v4, v4, v24, v25
    v_max3_f32 v4, v4, v26, v27
    v_max3_f32 v4, v4, v28, v29
    v_max3_f32 v4, v4, v30, v31
    v_max3_f32 v4, v4, v32, v33
    v_max3_f32 v4, v4, v34, v35
    v_max3_f32 v4, v4, v36, v37
    v_max3_f32 v4, v4, v38, v39
    s_cmp_eq_u32 s28, 2
    s_cbranch_scc1 L_ab_sm_74
    ds_read_b128 v[144:147], v11 offset:20480
    ds_read_b128 v[148:151], v11 offset:21504
    s_waitcnt lgkmcnt(0)
    v_mfma_f32_32x32x16_bf16 v[24:39], v[144:147], v[224:227], 0
    v_mfma_f32_32x32x16_bf16 v[24:39], v[148:151], v[228:231], v[24:39]
    s_nop 15
    v_max3_f32 v4, v4, v24, v25
    v_max3_f32 v4, v4, v26, v27
    v_max3_f32 v4, v4, v28, v29
    v_max3_f32 v4, v4, v30, v31
    v_max3_f32 v4, v4, v32, v33
    v_max3_f32 v4, v4, v34, v35
    v_max3_f32 v4, v4, v36, v37
    v_max3_f32 v4, v4, v38, v39
    s_cmp_eq_u32 s28, 3
    s_cbranch_scc1 L_ab_sm_74
    ds_read_b128 v[144:147], v11 offset:16384
    ds_read_b128 v[148:151], v11 offset:17408
    s_waitcnt lgkmcnt(0)
    v_mfma_f32_32x32x16_bf16 v[24:39], v[144:147], v[224:227], 0
    v_mfma_f32_32x32x16_bf16 v[24:39], v[148:151], v[228:231], v[24:39]
    s_nop 15
    v_max3_f32 v4, v4, v24, v25
    v_max3_f32 v4, v4, v26, v27
    v_max3_f32 v4, v4, v28, v29
    v_max3_f32 v4, v4, v30, v31
    v_max3_f32 v4, v4, v32, v33
    v_max3_f32 v4, v4, v34, v35
    v_max3_f32 v4, v4, v36, v37
    v_max3_f32 v4, v4, v38, v39
    s_cmp_eq_u32 s28, 4
    s_cbranch_scc1 L_ab_sm_74
    ds_read_b128 v[144:147], v11 offset:12288
    ds_read_b128 v[148:151], v11 offset:13312
    s_waitcnt lgkmcnt(0)
    v_mfma_f32_32x32x16_bf16 v[24:39], v[144:147], v[224:227], 0
    v_mfma_f32_32x32x16_bf16 v[24:39], v[148:151], v[228:231], v[24:39]
    s_nop 15
    v_max3_f32 v4, v4, v24, v25
    v_max3_f32 v4, v4, v26, v27
    v_max3_f32 v4, v4, v28, v29
    v_max3_f32 v4, v4, v30, v31
    v_max3_f32 v4, v4, v32, v33
    v_max3_f32 v4, v4, v34, v35
    v_max3_f32 v4, v4, v36, v37
    v_max3_f32 v4, v4, v38, v39
    s_cmp_eq_u32 s28, 5
    s_cbranch_scc1 L_ab_sm_74
    ds_read_b128 v[144:147], v11 offset:8192
    ds_read_b128 v[148:151], v11 offset:9216
    s_waitcnt lgkmcnt(0)
    v_mfma_f32_32x32x16_bf16 v[24:39], v[144:147], v[224:227], 0
    v_mfma_f32_32x32x16_bf16 v[24:39], v[148:151], v[228:231], v[24:39]
    s_nop 15
    v_max3_f32 v4, v4, v24, v25
    v_max3_f32 v4, v4, v26, v27
    v_max3_f32 v4, v4, v28, v29
    v_max3_f32 v4, v4, v30, v31
    v_max3_f32 v4, v4, v32, v33
    v_max3_f32 v4, v4, v34, v35
    v_max3_f32 v4, v4, v36, v37
    v_max3_f32 v4, v4, v38, v39
    s_cmp_eq_u32 s28, 6
    s_cbranch_scc1 L_ab_sm_74
    ds_read_b128 v[144:147], v11 offset:4096
    ds_read_b128 v[148:151], v11 offset:5120
    s_waitcnt lgkmcnt(0)
    v_mfma_f32_32x32x16_bf16 v[24:39], v[144:147], v[224:227], 0
    v_mfma_f32_32x32x16_bf16 v[24:39], v[148:151], v[228:231], v[24:39]
    s_nop 15
    v_max3_f32 v4, v4, v24, v25
    v_max3_f32 v4, v4, v26, v27
    v_max3_f32 v4, v4, v28, v29
    v_max3_f32 v4, v4, v30, v31
    v_max3_f32 v4, v4, v32, v33
    v_max3_f32 v4, v4, v34, v35
    v_max3_f32 v4, v4, v36, v37
    v_max3_f32 v4, v4, v38, v39
    s_cmp_eq_u32 s28, 7
    s_cbranch_scc1 L_ab_sm_74
    ds_read_b128 v[144:147], v11 offset:0
    ds_read_b128 v[148:151], v11 offset:1024
    s_waitcnt lgkmcnt(0)
    v_mfma_f32_32x32x16_bf16 v[24:39], v[144:147], v[224:227], v[96:111]
    v_mfma_f32_32x32x16_bf16 v[24:39], v[148:151], v[228:231], v[24:39]
    s_nop 15
    v_max3_f32 v4, v4, v24, v25
    v_max3_f32 v4, v4, v26, v27
    v_max3_f32 v4, v4, v28, v29
    v_max3_f32 v4, v4, v30, v31
    v_max3_f32 v4, v4, v32, v33
    v_max3_f32 v4, v4, v34, v35
    v_max3_f32 v4, v4, v36, v37
    v_max3_f32 v4, v4, v38, v39
L_ab_sm_74:
    v_mov_b32 v5, v4
    s_nop 1
    v_permlane32_swap_b32 v4, v5
    s_nop 1
    v_max_f32 v4, v4, v5
    s_mov_b32 exec_lo, 0
    v_and_b32 v5, 0xffff0000, v4
    v_sub_f32 v6, v4, v5
    v_and_b32 v7, 0xffff0000, v6
    v_sub_f32 v6, v6, v7
    v_lshrrev_b32 v5, 16, v5
    v_or_b32 v5, v5, v7
    v_lshrrev_b32 v6, 16, v6
    v_xor_b32 v230, 0x80008000, v5
    v_xor_b32 v231, 0x00008000, v6
    s_mov_b64 exec, -1
    s_branch L_ab_main_53
L_ho_r_109:
    s_add_u32 s35, s35, 1
    s_cmp_ge_u32 s35, 65536
    s_cbranch_scc1 L_ho_ok_110
    s_sleep 1
    s_branch L_ho_108
L_ofr_r_116:
    s_add_u32 s35, s35, 1
    s_cmp_ge_u32 s35, 65536
    s_cbranch_scc1 L_ofr_ok_117
    s_sleep 1
    s_branch L_ofr_115
L_op_redo_113:
    s_cmp_lg_u32 s53, 0
    s_cbranch_scc1 L_op_ok_114
    s_mov_b32 s53, 1
    s_barrier
    s_mov_b32 s35, 0
L_ofr_115:
    buffer_load_dwordx4 v[16:19], v1, s[8:11], s27 offen offset:0 sc1
    buffer_load_dwordx4 v[20:23], v1, s[8:11], s27 offen offset:1024 sc1
    buffer_load_dwordx4 v[24:27], v1, s[8:11], s27 offen offset:2048 sc1
    buffer_load_dwordx4 v[28:31], v1, s[8:11], s27 offen offset:3072 sc1
    s_add_u32 s29, s27, 4096
    buffer_load_dwordx4 v[32:35], v1, s[8:11], s29 offen offset:0 sc1
    buffer_load_dwordx4 v[36:39], v1, s[8:11], s29 offen offset:1024 sc1
    buffer_load_dwordx4 v[40:43], v1, s[8:11], s29 offen offset:2048 sc1
    buffer_load_dwordx4 v[44:47], v1, s[8:11], s29 offen offset:3072 sc1
    s_waitcnt vmcnt(0)
    v_max3_u32 v180, v16, v17, v18
    v_max3_u32 v180, v180, v19, v20
    v_max3_u32 v180, v180, v21, v22
    v_max3_u32 v180, v180, v23, v24
    v_max3_u32 v180, v180, v25, v26
    v_max3_u32 v180, v180, v27, v28
    v_max3_u32 v180, v180, v29, v30
    v_max3_u32 v180, v180, v31, v32
    v_max3_u32 v180, v180, v33, v34
    v_max3_u32 v180, v180, v35, v36
    v_max3_u32 v180, v180, v37, v38
    v_max3_u32 v180, v180, v39, v40
    v_max3_u32 v180, v180, v41, v42
    v_max3_u32 v180, v180, v43, v44
    v_max3_u32 v180, v180, v45, v46
    v_max_u32 v180, v180, v47
    v_cmp_eq_u32 vcc, -1, v180
    s_nop 1
    s_cmp_lg_u64 vcc, 0
    s_cbranch_scc1 L_ofr_r_116
L_ofr_ok_117:
    ds_write_b128 v176, v[16:19] offset:0
    ds_write_b128 v176, v[20:23] offset:1024
    ds_write_b128 v176, v[24:27] offset:2048
    ds_write_b128 v176, v[28:31] offset:3072
    ds_write_b128 v176, v[32:35] offset:4096
    ds_write_b128 v176, v[36:39] offset:5120
    ds_write_b128 v176, v[40:43] offset:6144
    ds_write_b128 v176, v[44:47] offset:7168
    s_waitcnt lgkmcnt(0)
    s_barrier
    s_branch L_op_mm_112
L_op_fin_118:
    s_lshl_b32 s21, s31, 5
    v_add_u32 v176, s21, v2
    v_mul_u32_u24 v176, 896, v176
    v_lshl_add_u32 v176, v3, 3, v176
    s_lshl_b32 s21, s32, 6
    buffer_store_dwordx2 v[240:241], v176, s[12:15], s21 offen offset:0
    buffer_store_dwordx2 v[242:243], v176, s[12:15], s21 offen offset:16
    buffer_store_dwordx2 v[244:245], v176, s[12:15], s21 offen offset:32
    buffer_store_dwordx2 v[246:247], v176, s[12:15], s21 offen offset:48
    s_branch L_op_skip_111
M_done:
    s_endpgm
.section .rodata,"a"
.p2align 6
.amdhsa_kernel prep_kernel
  .amdhsa_next_free_vgpr 48
  .amdhsa_next_free_sgpr 64
  .amdhsa_accum_offset 48
  .amdhsa_group_segment_fixed_size 0
  .amdhsa_kernarg_size 88
  .amdhsa_user_sgpr_count 2
  .amdhsa_user_sgpr_kernarg_segment_ptr 1
  .amdhsa_system_sgpr_workgroup_id_x 1
.end_amdhsa_kernel
.p2align 6
.amdhsa_kernel main_kernel
  .amdhsa_next_free_vgpr 496
  .amdhsa_next_free_sgpr 100
  .amdhsa_accum_offset 256
  .amdhsa_group_segment_fixed_size 0
  .amdhsa_kernarg_size 88
  .amdhsa_user_sgpr_count 2
  .amdhsa_user_sgpr_kernarg_segment_ptr 1
  .amdhsa_system_sgpr_workgroup_id_x 1
.end_amdhsa_kernel
```
